```python
import torch

def _softmax(x, axis=-1):
    return torch.softmax(x, dim=axis)
def _gelu(x):
    return torch.nn.functional.gelu(x, approximate="tanh")
def _silu(x):
    return torch.nn.functional.silu(x)
def _sigmoid(x):
    return torch.sigmoid(x)
def _layernorm(x, axis=-1, eps=1e-5):
    m = x.mean(dim=axis, keepdim=True)
    v = x.var(dim=axis, keepdim=True, unbiased=False)
    return (x - m) / torch.sqrt(v + eps)
def _scatter_add(tgt, idx, src, axis=0):
    return tgt.clone().index_add_(axis, idx, src)
def _segment_sum(src, seg, n):
    out = torch.zeros((n,) + src.shape[1:], dtype=src.dtype)
    return out.index_add_(0, seg, src)
def _pad(x, pw):
    flat = tuple(v for pair in reversed(pw) for v in pair)
    return torch.nn.functional.pad(x, flat)

kernel_name = 'gated_mix__mha_block__dense_activation_squared_relu__prompt'

def setup_inputs():

    _w = (lambda a: (lambda t: t.to(torch.bfloat16) if t.is_floating_point() else t)(torch.as_tensor(a)))
    def _A_setup():
        B, S, D, H = 1, 2048, 640, 32
        return {
            "x": _w((lambda *s: torch.randn(*s, dtype=torch.bfloat16) * 0.05)(B, S, D)),
            "wqkv": _w((lambda *s: torch.randn(*s, dtype=torch.bfloat16) * 0.8)(D, 3 * D)),
            "wo": _w((lambda *s: torch.randn(*s, dtype=torch.bfloat16) * 0.1)(D, D)),
        }
    _A_in = _A_setup()

    def _B_setup():
        B, S, D, F = 1, 2048, 640, 1536
        return {
            "x": _w((lambda *s: torch.randn(*s, dtype=torch.bfloat16) * 0.05)(B, S, D)),
            "w1": _w((lambda *s: torch.randn(*s, dtype=torch.bfloat16) * 0.1)(D, F)),
            "b1": _w((lambda *s: torch.randn(*s, dtype=torch.bfloat16) * 0.1)(F)),
            "w2": _w((lambda *s: torch.randn(*s, dtype=torch.bfloat16) * 0.1)(F, D)),
            "b2": _w((lambda *s: torch.randn(*s, dtype=torch.bfloat16) * 0.05)(D)),
        }
    _B_in = _B_setup()

    return {
        "A_x": _A_in["x"],
        "A_wqkv": _A_in["wqkv"],
        "A_wo": _A_in["wo"],
        "B_x": _B_in["x"],
        "B_w1": _B_in["w1"],
        "B_b1": _B_in["b1"],
        "B_w2": _B_in["w2"],
        "B_b2": _B_in["b2"],
        "gate_w": _w((lambda *s: torch.randn(*s, dtype=torch.bfloat16) * 0.05)(640) * 16.0),
    }

def reference(A_x, A_wqkv, A_wo, B_x, B_w1, B_b1, B_w2, B_b2, gate_w):
    def _A_ref(x, wqkv, wo):
        B, S, D = x.shape
        H = 32
        Dh = D // H
        qkv = (lambda x, *d: x.permute(*d))((x @ wqkv).reshape(B, S, 3, H, Dh), 2, 0, 3, 1, 4)
        q, k, v = qkv[0], qkv[1], qkv[2]
        scores = torch.einsum("bhqd,bhkd->bhqk", q, k) * (Dh ** -0.5)
        p = _softmax(scores, axis=-1)
        o = torch.einsum("bhqk,bhkd->bhqd", p, v)
        return (lambda x, *d: x.permute(*d))(o, 0, 2, 1, 3).reshape(B, S, D) @ wo

    def _B_ref(x, w1, b1, w2, b2):
        h = torch.einsum("bsd,df->bsf", x, w1) + b1
        zero = torch.zeros_like(h)
        r = torch.where(h > zero, h, zero)
        h = r * r
        out = torch.einsum("bsf,fd->bsd", h, w2) + b2
        return out

    x = A_x
    g = _sigmoid((x * gate_w).sum(-1, keepdims=True))
    a = _A_ref(x, A_wqkv, A_wo)
    b = _B_ref(x, B_w1, B_b1, B_w2, B_b2)
    return g * a + (1 - g) * b
```

```asm
; @launch kernel=qkv_kernel grid=(256,1,1) block=(512,1,1) lds=131072
; @launch kernel=main_kernel grid=(512,1,1) block=(512,1,1) lds=75264
.amdgcn_target "amdgcn-amd-amdhsa--gfx950"
.text
.globl qkv_kernel
.p2align 8
.type qkv_kernel,@function
qkv_kernel:
  s_cmp_ge_u32 s2, 256
  s_cbranch_scc1 qkv_kernel_exit
  s_load_dwordx2 s[4:5], s[0:1], 0
  s_load_dwordx2 s[8:9], s[0:1], 8
  s_load_dwordx2 s[12:13], s[0:1], 88
  s_and_b32 s29, s2, 7
  s_lshr_b32 s30, s2, 3
  s_lshr_b32 s16, s29, 1
  s_lshl_b32 s16, s16, 2
  s_and_b32 s19, s30, 3
  s_add_u32 s16, s16, s19
  s_and_b32 s17, s29, 1
  s_lshl_b32 s17, s17, 3
  s_lshr_b32 s20, s30, 2
  s_add_u32 s17, s17, s20
  v_lshrrev_b32 v2, 6, v0
  v_and_b32 v1, 63, v0
  v_readfirstlane_b32 s18, v2
  s_cmp_ge_u32 s17, 15
  s_cbranch_scc1 qkv_kernel_idle
  s_nop 1
  s_cmp_lt_u32 s18, 4
  s_cbranch_scc1 qkv_kernel_compute
  s_sub_u32 s18, s18, 4
  v_lshrrev_b32 v2, 3, v1
  v_lshrrev_b32 v3, 4, v1
  v_and_b32 v4, 7, v1
  s_lshl_b32 s19, s16, 7
  s_lshl_b32 s20, s18, 5
  s_add_u32 s19, s19, s20
  v_add_u32 v2, s19, v2
  v_mul_u32_u24 v2, 1280, v2
  v_xor_b32 v5, v4, v3
  v_lshl_add_u32 v6, v5, 4, v2
  v_xor_b32 v5, 4, v5
  v_lshl_add_u32 v7, v5, 4, v2
  v_add_u32 v7, 9216, v7
  v_add_u32 v8, 18432, v6
  v_add_u32 v9, 18432, v7
  v_and_b32 v4, 15, v1
  v_lshlrev_b32 v5, 2, v3
  v_xor_b32 v4, v4, v5
  s_lshl_b32 s19, s18, 4
  v_add_u32 v3, s19, v3
  v_mul_u32_u24 v3, 3840, v3
  v_lshl_add_u32 v10, v4, 4, v3
  s_lshl_b32 s19, s17, 8
  v_add_u32 v10, s19, v10
  v_add_u32 v11, 14336, v10
  v_add_u32 v12, 28672, v10
  v_add_u32 v13, 43008, v10
  s_lshl_b32 s21, s18, 12
  s_add_u32 s22, s21, 16384
  s_waitcnt lgkmcnt(0)
  s_mov_b32 s6, 2621440
  s_mov_b32 s7, 0x20000
  s_mov_b32 s10, 2457600
  s_mov_b32 s11, 0x20000
  s_mov_b32 s14, 268435456
  s_mov_b32 s15, 0x20000
  s_add_u32 s31, s16, s17
  s_mul_i32 s19, s31, 6554
  s_lshr_b32 s19, s19, 16
  s_mul_i32 s19, s19, 10
  s_sub_u32 s31, s31, s19
  s_mul_i32 s31, s31, 1
  s_mov_b32 s35, 0
  s_add_u32 m0, s21, s35
  s_lshl_b32 s23, s31, 7
  s_mul_i32 s24, s31, 245760
  s_add_u32 s31, s31, 1
  s_cmp_eq_u32 s31, 10
  s_cselect_b32 s31, 0, s31
  buffer_load_dwordx4 v6, s[4:7], s23 offen offset:0 lds
  buffer_load_dwordx4 v7, s[4:7], s23 offen offset:1024 lds
  buffer_load_dwordx4 v8, s[4:7], s23 offen offset:2048 lds
  buffer_load_dwordx4 v9, s[4:7], s23 offen offset:3072 lds
  s_add_u32 m0, s22, s35
  s_add_u32 s35, s35, 32768
  buffer_load_dwordx4 v10, s[8:11], s24 offen offset:0 lds
  buffer_load_dwordx4 v11, s[8:11], s24 offen offset:1024 lds
  buffer_load_dwordx4 v12, s[8:11], s24 offen offset:2048 lds
  buffer_load_dwordx4 v13, s[8:11], s24 offen offset:3072 lds
  s_and_b32 s35, s35, 131071
  s_add_u32 m0, s21, s35
  s_lshl_b32 s23, s31, 7
  s_mul_i32 s24, s31, 245760
  s_add_u32 s31, s31, 1
  s_cmp_eq_u32 s31, 10
  s_cselect_b32 s31, 0, s31
  buffer_load_dwordx4 v6, s[4:7], s23 offen offset:0 lds
  buffer_load_dwordx4 v7, s[4:7], s23 offen offset:1024 lds
  buffer_load_dwordx4 v8, s[4:7], s23 offen offset:2048 lds
  buffer_load_dwordx4 v9, s[4:7], s23 offen offset:3072 lds
  s_add_u32 m0, s22, s35
  s_add_u32 s35, s35, 32768
  buffer_load_dwordx4 v10, s[8:11], s24 offen offset:0 lds
  buffer_load_dwordx4 v11, s[8:11], s24 offen offset:1024 lds
  buffer_load_dwordx4 v12, s[8:11], s24 offen offset:2048 lds
  buffer_load_dwordx4 v13, s[8:11], s24 offen offset:3072 lds
  s_and_b32 s35, s35, 131071
  s_waitcnt vmcnt(8)
  s_barrier
  s_add_u32 m0, s21, s35
  s_lshl_b32 s23, s31, 7
  s_mul_i32 s24, s31, 245760
  s_add_u32 s31, s31, 1
  s_cmp_eq_u32 s31, 10
  s_cselect_b32 s31, 0, s31
  buffer_load_dwordx4 v6, s[4:7], s23 offen offset:0 lds
  buffer_load_dwordx4 v7, s[4:7], s23 offen offset:1024 lds
  buffer_load_dwordx4 v8, s[4:7], s23 offen offset:2048 lds
  buffer_load_dwordx4 v9, s[4:7], s23 offen offset:3072 lds
  s_add_u32 m0, s22, s35
  s_add_u32 s35, s35, 32768
  buffer_load_dwordx4 v10, s[8:11], s24 offen offset:0 lds
  buffer_load_dwordx4 v11, s[8:11], s24 offen offset:1024 lds
  buffer_load_dwordx4 v12, s[8:11], s24 offen offset:2048 lds
  buffer_load_dwordx4 v13, s[8:11], s24 offen offset:3072 lds
  s_and_b32 s35, s35, 131071
  s_mov_b32 s34, 7
qkv_kernel_ll:
  s_waitcnt vmcnt(8)
  s_barrier
  s_add_u32 m0, s21, s35
  s_lshl_b32 s23, s31, 7
  s_mul_i32 s24, s31, 245760
  s_add_u32 s31, s31, 1
  s_cmp_eq_u32 s31, 10
  s_cselect_b32 s31, 0, s31
  buffer_load_dwordx4 v6, s[4:7], s23 offen offset:0 lds
  buffer_load_dwordx4 v7, s[4:7], s23 offen offset:1024 lds
  buffer_load_dwordx4 v8, s[4:7], s23 offen offset:2048 lds
  buffer_load_dwordx4 v9, s[4:7], s23 offen offset:3072 lds
  s_add_u32 m0, s22, s35
  s_add_u32 s35, s35, 32768
  buffer_load_dwordx4 v10, s[8:11], s24 offen offset:0 lds
  buffer_load_dwordx4 v11, s[8:11], s24 offen offset:1024 lds
  buffer_load_dwordx4 v12, s[8:11], s24 offen offset:2048 lds
  buffer_load_dwordx4 v13, s[8:11], s24 offen offset:3072 lds
  s_and_b32 s35, s35, 131071
  s_sub_u32 s34, s34, 1
  s_cmp_lg_u32 s34, 0
  s_cbranch_scc1 qkv_kernel_ll
  s_waitcnt vmcnt(8)
  s_barrier
  s_waitcnt vmcnt(0)
  s_barrier
  s_barrier
  s_endpgm
qkv_kernel_compute:
  s_waitcnt lgkmcnt(0)
  s_mov_b32 s14, 268435456
  s_mov_b32 s15, 0x20000
  v_and_b32 v2, 31, v1
  v_lshrrev_b32 v3, 5, v1
  v_bfe_u32 v4, v2, 1, 3
  v_xor_b32 v4, v4, v3
  v_lshlrev_b32 v4, 4, v4
  s_and_b32 s19, s18, 1
  s_lshl_b32 s19, s19, 13
  v_lshl_add_u32 v2, v2, 7, v4
  v_add_u32 v6, s19, v2
  v_xor_b32 v7, 32, v6
  v_xor_b32 v8, 64, v6
  v_xor_b32 v9, 96, v6
  v_lshrrev_b32 v2, 4, v1
  v_and_b32 v3, 1, v2
  v_lshrrev_b32 v2, 1, v2
  v_bfe_u32 v4, v1, 2, 2
  v_lshl_add_u32 v2, v2, 3, v4
  v_lshlrev_b32 v2, 8, v2
  v_bfe_u32 v5, v1, 1, 1
  v_lshl_add_u32 v3, v3, 1, v5
  s_lshr_b32 s19, s18, 1
  s_lshl_b32 s20, s19, 3
  v_add_u32 v3, s20, v3
  v_lshlrev_b32 v4, 2, v4
  v_xor_b32 v3, v3, v4
  v_lshl_add_u32 v2, v3, 4, v2
  v_and_b32 v5, 1, v1
  v_lshl_add_u32 v2, v5, 3, v2
  v_add_u32 v14, 16384, v2
  v_xor_b32 v118, 64, v14
  s_cmp_ge_u32 s17, 10
  s_cbranch_scc1 qkv_kernel_vtype
  s_cmp_ge_u32 s17, 5
  s_mov_b32 s25, 0x3ea52b5c
  s_cmov_b32 s25, 1.0
  s_mov_b32 s26, 123392
  s_mov_b32 s28, 1280
  s_mov_b32 s27, 0
  s_cmov_b32 s27, 40960
  s_cselect_b32 s19, 5, 0
  s_sub_u32 s19, s17, s19
  s_lshl_b32 s19, s19, 5
  s_lshr_b32 s20, s18, 1
  s_lshl_b32 s20, s20, 4
  s_add_u32 s19, s19, s20
  v_lshrrev_b32 v2, 5, v1
  v_add_u32 v2, s19, v2
  v_and_b32 v3, 31, v1
  s_lshl_b32 s19, s16, 2
  s_and_b32 s20, s18, 1
  s_lshl_b32 s20, s20, 1
  s_add_u32 s19, s19, s20
  s_mul_i32 s19, s19, s26
  s_add_u32 s27, s27, s19
  v_lshrrev_b32 v4, 1, v1
  v_xor_b32 v4, v4, v1
  v_and_b32 v4, 1, v4
  v_mul_u32_u24 v4, 0x18, v4
  v_xor_b32 v14, v14, v4
  v_xor_b32 v118, v118, v4
  v_lshrrev_b32 v5, 5, v1
  v_sub_u32 v2, v2, v5
  v_lshrrev_b32 v2, 1, v2
  v_add_u32 v2, v2, v5
  v_add_u32 v4, 0, v2
  v_mul_u32_u24 v5, 205, v4
  v_lshrrev_b32 v5, 10, v5
  v_mul_u32_u24 v120, 5, v5
  v_sub_u32 v4, v4, v120
  v_mul_u32_u24 v120, 2560, v5
  v_add_u32 v120, s27, v120
  v_cmp_lt_u32 vcc, 2, v4
  v_subrev_u32 v5, 1, v4
  s_nop 0
  v_cndmask_b32 v5, v4, v5, vcc
  v_cmp_eq_u32 vcc, 2, v4
  s_nop 1
  v_cndmask_b32 v5, v5, 4, vcc
  v_lshl_add_u32 v120, v5, 9, v120
  v_lshl_add_u32 v120, v3, 4, v120
  v_add_u32 v4, 2, v2
  v_mul_u32_u24 v5, 205, v4
  v_lshrrev_b32 v5, 10, v5
  v_mul_u32_u24 v121, 5, v5
  v_sub_u32 v4, v4, v121
  v_mul_u32_u24 v121, 2560, v5
  v_add_u32 v121, s27, v121
  v_cmp_lt_u32 vcc, 2, v4
  v_subrev_u32 v5, 1, v4
  s_nop 0
  v_cndmask_b32 v5, v4, v5, vcc
  v_cmp_eq_u32 vcc, 2, v4
  s_nop 1
  v_cndmask_b32 v5, v5, 4, vcc
  v_lshl_add_u32 v121, v5, 9, v121
  v_lshl_add_u32 v121, v3, 4, v121
  v_add_u32 v4, 4, v2
  v_mul_u32_u24 v5, 205, v4
  v_lshrrev_b32 v5, 10, v5
  v_mul_u32_u24 v122, 5, v5
  v_sub_u32 v4, v4, v122
  v_mul_u32_u24 v122, 2560, v5
  v_add_u32 v122, s27, v122
  v_cmp_lt_u32 vcc, 2, v4
  v_subrev_u32 v5, 1, v4
  s_nop 0
  v_cndmask_b32 v5, v4, v5, vcc
  v_cmp_eq_u32 vcc, 2, v4
  s_nop 1
  v_cndmask_b32 v5, v5, 4, vcc
  v_lshl_add_u32 v122, v5, 9, v122
  v_lshl_add_u32 v122, v3, 4, v122
  v_add_u32 v4, 6, v2
  v_mul_u32_u24 v5, 205, v4
  v_lshrrev_b32 v5, 10, v5
  v_mul_u32_u24 v123, 5, v5
  v_sub_u32 v4, v4, v123
  v_mul_u32_u24 v123, 2560, v5
  v_add_u32 v123, s27, v123
  v_cmp_lt_u32 vcc, 2, v4
  v_subrev_u32 v5, 1, v4
  s_nop 0
  v_cndmask_b32 v5, v4, v5, vcc
  v_cmp_eq_u32 vcc, 2, v4
  s_nop 1
  v_cndmask_b32 v5, v5, 4, vcc
  v_lshl_add_u32 v123, v5, 9, v123
  v_lshl_add_u32 v123, v3, 4, v123
  buffer_load_dword v16, v120, s[12:15], 0 offen
  buffer_load_dword v16, v123, s[12:15], s26 offen
  v_mov_b32 v50, 0
  v_mov_b32 v51, 0
  v_mov_b32 v52, 0
  v_mov_b32 v53, 0
  v_mov_b32 v54, 0
  v_mov_b32 v55, 0
  v_mov_b32 v56, 0
  v_mov_b32 v57, 0
  v_mov_b32 v58, 0
  v_mov_b32 v59, 0
  v_mov_b32 v60, 0
  v_mov_b32 v61, 0
  v_mov_b32 v62, 0
  v_mov_b32 v63, 0
  v_mov_b32 v64, 0
  v_mov_b32 v65, 0
  v_mov_b32 v66, 0
  v_mov_b32 v67, 0
  v_mov_b32 v68, 0
  v_mov_b32 v69, 0
  v_mov_b32 v70, 0
  v_mov_b32 v71, 0
  v_mov_b32 v72, 0
  v_mov_b32 v73, 0
  v_mov_b32 v74, 0
  v_mov_b32 v75, 0
  v_mov_b32 v76, 0
  v_mov_b32 v77, 0
  v_mov_b32 v78, 0
  v_mov_b32 v79, 0
  v_mov_b32 v80, 0
  v_mov_b32 v81, 0
  v_mov_b32 v82, 0
  v_mov_b32 v83, 0
  v_mov_b32 v84, 0
  v_mov_b32 v85, 0
  v_mov_b32 v86, 0
  v_mov_b32 v87, 0
  v_mov_b32 v88, 0
  v_mov_b32 v89, 0
  v_mov_b32 v90, 0
  v_mov_b32 v91, 0
  v_mov_b32 v92, 0
  v_mov_b32 v93, 0
  v_mov_b32 v94, 0
  v_mov_b32 v95, 0
  v_mov_b32 v96, 0
  v_mov_b32 v97, 0
  v_mov_b32 v98, 0
  v_mov_b32 v99, 0
  v_mov_b32 v100, 0
  v_mov_b32 v101, 0
  v_mov_b32 v102, 0
  v_mov_b32 v103, 0
  v_mov_b32 v104, 0
  v_mov_b32 v105, 0
  v_mov_b32 v106, 0
  v_mov_b32 v107, 0
  v_mov_b32 v108, 0
  v_mov_b32 v109, 0
  v_mov_b32 v110, 0
  v_mov_b32 v111, 0
  v_mov_b32 v112, 0
  v_mov_b32 v113, 0
  s_mov_b32 s34, 10
  s_mov_b32 s35, 0
  s_waitcnt lgkmcnt(0)
  s_barrier
  ds_read_b128 v[18:21], v6
  ds_read_b64_tr_b16 v[26:27], v14 offset:0
  ds_read_b64_tr_b16 v[28:29], v14 offset:1024
  ds_read_b128 v[22:25], v6 offset:4096
  ds_read_b64_tr_b16 v[30:31], v118 offset:0
  ds_read_b64_tr_b16 v[32:33], v118 offset:1024
.p2align 6
qkv_kernel_clk:
  ds_read_b128 v[34:37], v7
  ds_read_b64_tr_b16 v[42:43], v14 offset:4096
  ds_read_b64_tr_b16 v[44:45], v14 offset:5120
  ds_read_b128 v[38:41], v7 offset:4096
  ds_read_b64_tr_b16 v[46:47], v118 offset:4096
  ds_read_b64_tr_b16 v[48:49], v118 offset:5120
  s_waitcnt lgkmcnt(6)
  v_mfma_f32_32x32x16_bf16 v[50:65], v[26:29], v[18:21], v[50:65]
  v_mfma_f32_32x32x16_bf16 v[66:81], v[26:29], v[22:25], v[66:81]
  v_mfma_f32_32x32x16_bf16 v[82:97], v[30:33], v[18:21], v[82:97]
  v_mfma_f32_32x32x16_bf16 v[98:113], v[30:33], v[22:25], v[98:113]
  ds_read_b128 v[18:21], v8
  ds_read_b64_tr_b16 v[26:27], v14 offset:8192
  ds_read_b64_tr_b16 v[28:29], v14 offset:9216
  ds_read_b128 v[22:25], v8 offset:4096
  ds_read_b64_tr_b16 v[30:31], v118 offset:8192
  ds_read_b64_tr_b16 v[32:33], v118 offset:9216
  s_waitcnt lgkmcnt(6)
  v_mfma_f32_32x32x16_bf16 v[50:65], v[42:45], v[34:37], v[50:65]
  v_mfma_f32_32x32x16_bf16 v[66:81], v[42:45], v[38:41], v[66:81]
  v_mfma_f32_32x32x16_bf16 v[82:97], v[46:49], v[34:37], v[82:97]
  v_mfma_f32_32x32x16_bf16 v[98:113], v[46:49], v[38:41], v[98:113]
  ds_read_b128 v[34:37], v9
  ds_read_b64_tr_b16 v[42:43], v14 offset:12288
  ds_read_b64_tr_b16 v[44:45], v14 offset:13312
  ds_read_b128 v[38:41], v9 offset:4096
  ds_read_b64_tr_b16 v[46:47], v118 offset:12288
  ds_read_b64_tr_b16 v[48:49], v118 offset:13312
  s_waitcnt lgkmcnt(6)
  v_mfma_f32_32x32x16_bf16 v[50:65], v[26:29], v[18:21], v[50:65]
  v_mfma_f32_32x32x16_bf16 v[66:81], v[26:29], v[22:25], v[66:81]
  v_mfma_f32_32x32x16_bf16 v[82:97], v[30:33], v[18:21], v[82:97]
  v_mfma_f32_32x32x16_bf16 v[98:113], v[30:33], v[22:25], v[98:113]
  s_barrier
  s_add_u32 s35, s35, 32768
  s_cmp_eq_u32 s35, 131072
  s_cselect_b32 s35, 0, s35
  s_mov_b32 s33, 32768
  s_cmov_b32 s33, -98304
  v_add_u32 v6, s33, v6
  v_add_u32 v7, s33, v7
  v_add_u32 v8, s33, v8
  v_add_u32 v9, s33, v9
  v_add_u32 v14, s33, v14
  v_add_u32 v118, s33, v118
  ds_read_b128 v[18:21], v6
  ds_read_b64_tr_b16 v[26:27], v14 offset:0
  ds_read_b64_tr_b16 v[28:29], v14 offset:1024
  ds_read_b128 v[22:25], v6 offset:4096
  ds_read_b64_tr_b16 v[30:31], v118 offset:0
  ds_read_b64_tr_b16 v[32:33], v118 offset:1024
  s_waitcnt lgkmcnt(6)
  v_mfma_f32_32x32x16_bf16 v[50:65], v[42:45], v[34:37], v[50:65]
  v_mfma_f32_32x32x16_bf16 v[66:81], v[42:45], v[38:41], v[66:81]
  v_mfma_f32_32x32x16_bf16 v[82:97], v[46:49], v[34:37], v[82:97]
  v_mfma_f32_32x32x16_bf16 v[98:113], v[46:49], v[38:41], v[98:113]
  s_sub_u32 s34, s34, 1
  s_cmp_lg_u32 s34, 0
  s_cbranch_scc1 qkv_kernel_clk
  s_waitcnt lgkmcnt(0)
  s_nop 15
  s_nop 3
  s_mov_b32 s19, s26
  v_mul_f32 v50, s25, v50
  v_mul_f32 v51, s25, v51
  v_mul_f32 v52, s25, v52
  v_mul_f32 v53, s25, v53
  v_mul_f32 v54, s25, v54
  v_mul_f32 v55, s25, v55
  v_mul_f32 v56, s25, v56
  v_mul_f32 v57, s25, v57
  v_cvt_pk_bf16_f32 v18, v50, v51
  v_cvt_pk_bf16_f32 v19, v52, v53
  v_cvt_pk_bf16_f32 v20, v54, v55
  v_cvt_pk_bf16_f32 v21, v56, v57
  buffer_store_dwordx4 v[18:21], v120, s[12:15], 0 offen sc1
  v_mul_f32 v58, s25, v58
  v_mul_f32 v59, s25, v59
  v_mul_f32 v60, s25, v60
  v_mul_f32 v61, s25, v61
  v_mul_f32 v62, s25, v62
  v_mul_f32 v63, s25, v63
  v_mul_f32 v64, s25, v64
  v_mul_f32 v65, s25, v65
  v_cvt_pk_bf16_f32 v22, v58, v59
  v_cvt_pk_bf16_f32 v23, v60, v61
  v_cvt_pk_bf16_f32 v24, v62, v63
  v_cvt_pk_bf16_f32 v25, v64, v65
  buffer_store_dwordx4 v[22:25], v121, s[12:15], 0 offen sc1
  v_mul_f32 v66, s25, v66
  v_mul_f32 v67, s25, v67
  v_mul_f32 v68, s25, v68
  v_mul_f32 v69, s25, v69
  v_mul_f32 v70, s25, v70
  v_mul_f32 v71, s25, v71
  v_mul_f32 v72, s25, v72
  v_mul_f32 v73, s25, v73
  v_cvt_pk_bf16_f32 v26, v66, v67
  v_cvt_pk_bf16_f32 v27, v68, v69
  v_cvt_pk_bf16_f32 v28, v70, v71
  v_cvt_pk_bf16_f32 v29, v72, v73
  buffer_store_dwordx4 v[26:29], v120, s[12:15], s19 offen sc1
  v_mul_f32 v74, s25, v74
  v_mul_f32 v75, s25, v75
  v_mul_f32 v76, s25, v76
  v_mul_f32 v77, s25, v77
  v_mul_f32 v78, s25, v78
  v_mul_f32 v79, s25, v79
  v_mul_f32 v80, s25, v80
  v_mul_f32 v81, s25, v81
  v_cvt_pk_bf16_f32 v30, v74, v75
  v_cvt_pk_bf16_f32 v31, v76, v77
  v_cvt_pk_bf16_f32 v32, v78, v79
  v_cvt_pk_bf16_f32 v33, v80, v81
  buffer_store_dwordx4 v[30:33], v121, s[12:15], s19 offen sc1
  v_mul_f32 v82, s25, v82
  v_mul_f32 v83, s25, v83
  v_mul_f32 v84, s25, v84
  v_mul_f32 v85, s25, v85
  v_mul_f32 v86, s25, v86
  v_mul_f32 v87, s25, v87
  v_mul_f32 v88, s25, v88
  v_mul_f32 v89, s25, v89
  v_cvt_pk_bf16_f32 v34, v82, v83
  v_cvt_pk_bf16_f32 v35, v84, v85
  v_cvt_pk_bf16_f32 v36, v86, v87
  v_cvt_pk_bf16_f32 v37, v88, v89
  buffer_store_dwordx4 v[34:37], v122, s[12:15], 0 offen sc1
  v_mul_f32 v90, s25, v90
  v_mul_f32 v91, s25, v91
  v_mul_f32 v92, s25, v92
  v_mul_f32 v93, s25, v93
  v_mul_f32 v94, s25, v94
  v_mul_f32 v95, s25, v95
  v_mul_f32 v96, s25, v96
  v_mul_f32 v97, s25, v97
  v_cvt_pk_bf16_f32 v38, v90, v91
  v_cvt_pk_bf16_f32 v39, v92, v93
  v_cvt_pk_bf16_f32 v40, v94, v95
  v_cvt_pk_bf16_f32 v41, v96, v97
  buffer_store_dwordx4 v[38:41], v123, s[12:15], 0 offen sc1
  v_mul_f32 v98, s25, v98
  v_mul_f32 v99, s25, v99
  v_mul_f32 v100, s25, v100
  v_mul_f32 v101, s25, v101
  v_mul_f32 v102, s25, v102
  v_mul_f32 v103, s25, v103
  v_mul_f32 v104, s25, v104
  v_mul_f32 v105, s25, v105
  v_cvt_pk_bf16_f32 v42, v98, v99
  v_cvt_pk_bf16_f32 v43, v100, v101
  v_cvt_pk_bf16_f32 v44, v102, v103
  v_cvt_pk_bf16_f32 v45, v104, v105
  buffer_store_dwordx4 v[42:45], v122, s[12:15], s19 offen sc1
  v_mul_f32 v106, s25, v106
  v_mul_f32 v107, s25, v107
  v_mul_f32 v108, s25, v108
  v_mul_f32 v109, s25, v109
  v_mul_f32 v110, s25, v110
  v_mul_f32 v111, s25, v111
  v_mul_f32 v112, s25, v112
  v_mul_f32 v113, s25, v113
  v_cvt_pk_bf16_f32 v46, v106, v107
  v_cvt_pk_bf16_f32 v47, v108, v109
  v_cvt_pk_bf16_f32 v48, v110, v111
  v_cvt_pk_bf16_f32 v49, v112, v113
  buffer_store_dwordx4 v[46:49], v123, s[12:15], s19 offen sc1
  s_endpgm
qkv_kernel_vtype:
  s_sub_u32 s19, s17, 10
  s_lshl_b32 s19, s19, 7
  s_lshr_b32 s20, s18, 1
  s_lshl_b32 s20, s20, 6
  s_add_u32 s19, s19, s20
  v_and_b32 v2, 31, v1
  v_add_u32 v2, s19, v2
  s_lshl_b32 s19, s16, 2
  s_and_b32 s20, s18, 1
  s_lshl_b32 s20, s20, 1
  s_add_u32 s19, s19, s20
  s_mul_i32 s19, s19, 123392
  s_add_u32 s27, s19, 81920
  v_add_u32 v4, 0, v2
  v_mul_u32_u24 v3, 410, v4
  v_lshrrev_b32 v3, 16, v3
  v_mul_u32_u24 v5, 160, v3
  v_sub_u32 v5, v4, v5
  v_mul_u32_u24 v120, 10368, v3
  v_lshl_add_u32 v120, v5, 4, v120
  v_lshrrev_b32 v5, 5, v1
  v_mul_u32_u24 v5, 2560, v5
  v_add_u32 v120, v120, v5
  v_add_u32 v120, s27, v120
  v_add_u32 v4, 32, v2
  v_mul_u32_u24 v3, 410, v4
  v_lshrrev_b32 v3, 16, v3
  v_mul_u32_u24 v5, 160, v3
  v_sub_u32 v5, v4, v5
  v_mul_u32_u24 v121, 10368, v3
  v_lshl_add_u32 v121, v5, 4, v121
  v_lshrrev_b32 v5, 5, v1
  v_mul_u32_u24 v5, 2560, v5
  v_add_u32 v121, v121, v5
  v_add_u32 v121, s27, v121
  v_mov_b32 v124, 0x3f803f80
  v_mov_b32 v125, 0x3f803f80
  v_mov_b32 v126, 0x3f803f80
  v_mov_b32 v127, 0x3f803f80
  buffer_load_dword v16, v120, s[12:15], 0 offen
  v_mov_b32 v50, 0
  v_mov_b32 v51, 0
  v_mov_b32 v52, 0
  v_mov_b32 v53, 0
  v_mov_b32 v54, 0
  v_mov_b32 v55, 0
  v_mov_b32 v56, 0
  v_mov_b32 v57, 0
  v_mov_b32 v58, 0
  v_mov_b32 v59, 0
  v_mov_b32 v60, 0
  v_mov_b32 v61, 0
  v_mov_b32 v62, 0
  v_mov_b32 v63, 0
  v_mov_b32 v64, 0
  v_mov_b32 v65, 0
  v_mov_b32 v66, 0
  v_mov_b32 v67, 0
  v_mov_b32 v68, 0
  v_mov_b32 v69, 0
  v_mov_b32 v70, 0
  v_mov_b32 v71, 0
  v_mov_b32 v72, 0
  v_mov_b32 v73, 0
  v_mov_b32 v74, 0
  v_mov_b32 v75, 0
  v_mov_b32 v76, 0
  v_mov_b32 v77, 0
  v_mov_b32 v78, 0
  v_mov_b32 v79, 0
  v_mov_b32 v80, 0
  v_mov_b32 v81, 0
  v_mov_b32 v82, 0
  v_mov_b32 v83, 0
  v_mov_b32 v84, 0
  v_mov_b32 v85, 0
  v_mov_b32 v86, 0
  v_mov_b32 v87, 0
  v_mov_b32 v88, 0
  v_mov_b32 v89, 0
  v_mov_b32 v90, 0
  v_mov_b32 v91, 0
  v_mov_b32 v92, 0
  v_mov_b32 v93, 0
  v_mov_b32 v94, 0
  v_mov_b32 v95, 0
  v_mov_b32 v96, 0
  v_mov_b32 v97, 0
  v_mov_b32 v98, 0
  v_mov_b32 v99, 0
  v_mov_b32 v100, 0
  v_mov_b32 v101, 0
  v_mov_b32 v102, 0
  v_mov_b32 v103, 0
  v_mov_b32 v104, 0
  v_mov_b32 v105, 0
  v_mov_b32 v106, 0
  v_mov_b32 v107, 0
  v_mov_b32 v108, 0
  v_mov_b32 v109, 0
  v_mov_b32 v110, 0
  v_mov_b32 v111, 0
  v_mov_b32 v112, 0
  v_mov_b32 v113, 0
  s_mov_b32 s34, 10
  s_mov_b32 s35, 0
  s_waitcnt lgkmcnt(0)
  s_barrier
  ds_read_b128 v[18:21], v6
  ds_read_b64_tr_b16 v[26:27], v14 offset:0
  ds_read_b64_tr_b16 v[28:29], v14 offset:1024
  ds_read_b128 v[22:25], v6 offset:4096
  ds_read_b64_tr_b16 v[30:31], v118 offset:0
  ds_read_b64_tr_b16 v[32:33], v118 offset:1024
.p2align 6
qkv_kernel_clv:
  ds_read_b128 v[34:37], v7
  ds_read_b64_tr_b16 v[42:43], v14 offset:4096
  ds_read_b64_tr_b16 v[44:45], v14 offset:5120
  ds_read_b128 v[38:41], v7 offset:4096
  ds_read_b64_tr_b16 v[46:47], v118 offset:4096
  ds_read_b64_tr_b16 v[48:49], v118 offset:5120
  s_waitcnt lgkmcnt(6)
  v_mfma_f32_32x32x16_bf16 v[50:65], v[18:21], v[26:29], v[50:65]
  v_mfma_f32_32x32x16_bf16 v[66:81], v[22:25], v[26:29], v[66:81]
  v_mfma_f32_32x32x16_bf16 v[82:97], v[18:21], v[30:33], v[82:97]
  v_mfma_f32_32x32x16_bf16 v[98:113], v[22:25], v[30:33], v[98:113]
  ds_read_b128 v[18:21], v8
  ds_read_b64_tr_b16 v[26:27], v14 offset:8192
  ds_read_b64_tr_b16 v[28:29], v14 offset:9216
  ds_read_b128 v[22:25], v8 offset:4096
  ds_read_b64_tr_b16 v[30:31], v118 offset:8192
  ds_read_b64_tr_b16 v[32:33], v118 offset:9216
  s_waitcnt lgkmcnt(6)
  v_mfma_f32_32x32x16_bf16 v[50:65], v[34:37], v[42:45], v[50:65]
  v_mfma_f32_32x32x16_bf16 v[66:81], v[38:41], v[42:45], v[66:81]
  v_mfma_f32_32x32x16_bf16 v[82:97], v[34:37], v[46:49], v[82:97]
  v_mfma_f32_32x32x16_bf16 v[98:113], v[38:41], v[46:49], v[98:113]
  ds_read_b128 v[34:37], v9
  ds_read_b64_tr_b16 v[42:43], v14 offset:12288
  ds_read_b64_tr_b16 v[44:45], v14 offset:13312
  ds_read_b128 v[38:41], v9 offset:4096
  ds_read_b64_tr_b16 v[46:47], v118 offset:12288
  ds_read_b64_tr_b16 v[48:49], v118 offset:13312
  s_waitcnt lgkmcnt(6)
  v_mfma_f32_32x32x16_bf16 v[50:65], v[18:21], v[26:29], v[50:65]
  v_mfma_f32_32x32x16_bf16 v[66:81], v[22:25], v[26:29], v[66:81]
  v_mfma_f32_32x32x16_bf16 v[82:97], v[18:21], v[30:33], v[82:97]
  v_mfma_f32_32x32x16_bf16 v[98:113], v[22:25], v[30:33], v[98:113]
  s_barrier
  s_add_u32 s35, s35, 32768
  s_cmp_eq_u32 s35, 131072
  s_cselect_b32 s35, 0, s35
  s_mov_b32 s33, 32768
  s_cmov_b32 s33, -98304
  v_add_u32 v6, s33, v6
  v_add_u32 v7, s33, v7
  v_add_u32 v8, s33, v8
  v_add_u32 v9, s33, v9
  v_add_u32 v14, s33, v14
  v_add_u32 v118, s33, v118
  ds_read_b128 v[18:21], v6
  ds_read_b64_tr_b16 v[26:27], v14 offset:0
  ds_read_b64_tr_b16 v[28:29], v14 offset:1024
  ds_read_b128 v[22:25], v6 offset:4096
  ds_read_b64_tr_b16 v[30:31], v118 offset:0
  ds_read_b64_tr_b16 v[32:33], v118 offset:1024
  s_waitcnt lgkmcnt(6)
  v_mfma_f32_32x32x16_bf16 v[50:65], v[34:37], v[42:45], v[50:65]
  v_mfma_f32_32x32x16_bf16 v[66:81], v[38:41], v[42:45], v[66:81]
  v_mfma_f32_32x32x16_bf16 v[82:97], v[34:37], v[46:49], v[82:97]
  v_mfma_f32_32x32x16_bf16 v[98:113], v[38:41], v[46:49], v[98:113]
  s_sub_u32 s34, s34, 1
  s_cmp_lg_u32 s34, 0
  s_cbranch_scc1 qkv_kernel_clv
  s_waitcnt lgkmcnt(0)
  s_nop 15
  s_nop 3
  s_mov_b32 s20, 123392
  s_mov_b32 s33, 5120
  s_mov_b32 s34, 128512
  v_cvt_pk_bf16_f32 v18, v50, v51
  v_cvt_pk_bf16_f32 v19, v52, v53
  v_cvt_pk_bf16_f32 v20, v54, v55
  v_cvt_pk_bf16_f32 v21, v56, v57
  buffer_store_dwordx4 v[18:21], v120, s[12:15], 0 offen sc1
  v_cvt_pk_bf16_f32 v22, v58, v59
  v_cvt_pk_bf16_f32 v23, v60, v61
  v_cvt_pk_bf16_f32 v24, v62, v63
  v_cvt_pk_bf16_f32 v25, v64, v65
  buffer_store_dwordx4 v[22:25], v120, s[12:15], s33 offen sc1
  v_cvt_pk_bf16_f32 v26, v66, v67
  v_cvt_pk_bf16_f32 v27, v68, v69
  v_cvt_pk_bf16_f32 v28, v70, v71
  v_cvt_pk_bf16_f32 v29, v72, v73
  buffer_store_dwordx4 v[26:29], v120, s[12:15], s20 offen sc1
  v_cvt_pk_bf16_f32 v30, v74, v75
  v_cvt_pk_bf16_f32 v31, v76, v77
  v_cvt_pk_bf16_f32 v32, v78, v79
  v_cvt_pk_bf16_f32 v33, v80, v81
  buffer_store_dwordx4 v[30:33], v120, s[12:15], s34 offen sc1
  v_cvt_pk_bf16_f32 v34, v82, v83
  v_cvt_pk_bf16_f32 v35, v84, v85
  v_cvt_pk_bf16_f32 v36, v86, v87
  v_cvt_pk_bf16_f32 v37, v88, v89
  buffer_store_dwordx4 v[34:37], v121, s[12:15], 0 offen sc1
  v_cvt_pk_bf16_f32 v38, v90, v91
  v_cvt_pk_bf16_f32 v39, v92, v93
  v_cvt_pk_bf16_f32 v40, v94, v95
  v_cvt_pk_bf16_f32 v41, v96, v97
  buffer_store_dwordx4 v[38:41], v121, s[12:15], s33 offen sc1
  v_cvt_pk_bf16_f32 v42, v98, v99
  v_cvt_pk_bf16_f32 v43, v100, v101
  v_cvt_pk_bf16_f32 v44, v102, v103
  v_cvt_pk_bf16_f32 v45, v104, v105
  buffer_store_dwordx4 v[42:45], v121, s[12:15], s20 offen sc1
  v_cvt_pk_bf16_f32 v46, v106, v107
  v_cvt_pk_bf16_f32 v47, v108, v109
  v_cvt_pk_bf16_f32 v48, v110, v111
  v_cvt_pk_bf16_f32 v49, v112, v113
  buffer_store_dwordx4 v[46:49], v121, s[12:15], s34 offen sc1
  s_cmp_ge_u32 s17, 14
  s_cbranch_scc1 qkv_kernel_noones
  s_cmp_ge_u32 s18, 2
  s_cbranch_scc1 qkv_kernel_noones
  s_sub_u32 s19, s17, 10
  s_mul_i32 s19, s19, 10368
  s_add_u32 s19, s19, s27
  s_add_u32 s19, s19, 10240
  s_add_u32 s20, s19, 123392
  v_lshlrev_b32 v2, 4, v1
  s_mov_b64 exec, 0xff
  buffer_store_dwordx4 v[124:127], v2, s[12:15], s19 offen sc1
  buffer_store_dwordx4 v[124:127], v2, s[12:15], s20 offen sc1
  s_mov_b64 exec, -1
qkv_kernel_noones:
  s_endpgm
qkv_kernel_idle:
  s_cmp_lg_u32 s18, 0
  s_cbranch_scc1 qkv_kernel_inocp
  s_getpc_b64 s[36:37]
qkv_kernel_ipc:
  s_add_u32 s36, s36, main_kernel - qkv_kernel_ipc
  s_addc_u32 s37, s37, 0
  v_lshlrev_b32 v2, 7, v1
  global_load_dword v3, v2, s[36:37]
  v_add_u32 v2, 8192, v2
  global_load_dword v3, v2, s[36:37]
  v_add_u32 v2, 8192, v2
  s_mov_b64 exec, 0x3ffffff
  global_load_dword v3, v2, s[36:37]
  v_add_u32 v2, 8192, v2
  s_mov_b64 exec, -1
  s_load_dwordx2 s[64:65], s[0:1], 32
  s_load_dwordx2 s[66:67], s[0:1], 48
  s_load_dwordx2 s[68:69], s[0:1], 16
  s_load_dwordx2 s[70:71], s[0:1], 40
  s_load_dwordx2 s[72:73], s[0:1], 56
  s_load_dwordx2 s[74:75], s[0:1], 64
  s_load_dwordx2 s[76:77], s[0:1], 72
  v_mov_b32 v4, 0
  s_mov_b64 exec, 1
  s_waitcnt lgkmcnt(0)
  global_load_dword v3, v4, s[64:65]
  global_load_dword v3, v4, s[66:67]
  global_load_dword v3, v4, s[68:69]
  global_load_dword v3, v4, s[70:71]
  global_load_dword v3, v4, s[72:73]
  global_load_dword v3, v4, s[74:75]
  global_load_dword v3, v4, s[76:77]
  s_mov_b64 exec, -1
  s_waitcnt vmcnt(0)
qkv_kernel_inocp:
qkv_kernel_exit:
  s_endpgm
.section .rodata,"a"
.p2align 6
.amdhsa_kernel qkv_kernel
  .amdhsa_next_free_vgpr 128
  .amdhsa_next_free_sgpr 96
  .amdhsa_accum_offset 128
  .amdhsa_group_segment_fixed_size 0
  .amdhsa_kernarg_size 96
  .amdhsa_user_sgpr_count 2
  .amdhsa_user_sgpr_kernarg_segment_ptr 1
  .amdhsa_system_sgpr_workgroup_id_x 1
.end_amdhsa_kernel
.text
.globl main_kernel
.p2align 8
.type main_kernel,@function
main_kernel:
  s_cmp_ge_u32 s2, 512
  s_cbranch_scc1 fk_exit
  s_load_dwordx4 s[4:7], s[0:1], 0
  s_load_dwordx4 s[56:59], s[0:1], 80
  v_lshrrev_b32 v2, 6, v0
  v_and_b32 v1, 63, v0
  v_readfirstlane_b32 s18, v2
  s_mov_b32 s60, 0
  s_cmp_ge_u32 s2, 256
  s_cbranch_scc1 fk_frole
  s_mov_b32 s19, s2
  s_setprio 3
fk_att0:
fk_att:
  s_and_b32 s44, s19, 7
  s_lshl_b32 s44, s44, 2
  s_bfe_u32 s45, s19, 0x20003
  s_add_u32 s40, s44, s45
  s_lshr_b32 s41, s19, 5
  s_and_b32 s42, s18, 3
  s_lshr_b32 s43, s18, 2
  s_mul_i32 s47, s18, 2880
  s_mov_b32 s51, 0
  s_lshr_b32 s54, s40, 1
  s_mul_i32 s54, s54, 2560
  s_add_u32 s55, s54, 2048
  s_and_b32 s44, s40, 1
  s_lshl_b32 s44, s44, 10
  s_add_u32 s54, s54, s44
  s_add_u32 s44, s54, 40960
  s_lshr_b32 s45, s40, 3
  s_mul_i32 s45, s45, 10368
  s_add_u32 s45, s45, 81920
  s_and_b32 s48, s40, 7
  s_mul_i32 s48, s48, 320
  v_lshlrev_b32 v119, 4, v1
  v_add_u32 v119, s44, v119
  v_add_u32 v70, -32, v1
  v_max_i32 v71, 0, v70
  v_mul_u32_u24 v72, 3121, v71
  v_lshrrev_b32 v72, 16, v72
  v_mul_u32_u24 v73, 21, v72
  v_sub_u32 v73, v71, v73
  v_mul_u32_u24 v72, 2560, v72
  v_lshl_add_u32 v72, v73, 4, v72
  v_add_u32 v72, s48, v72
  v_cmp_eq_u32 vcc, 20, v73
  v_mov_b32 v74, 10240
  s_nop 0
  v_cndmask_b32 v72, v72, v74, vcc
  v_add_u32 v8, s45, v72
  v_lshlrev_b32 v74, 4, v1
  v_add_u32 v74, 40960, v74
  v_add_u32 v74, s55, v74
  v_cmp_gt_i32 vcc, 0, v70
  s_nop 1
  v_cndmask_b32 v8, v8, v74, vcc
  v_subrev_u32 v8, 1024, v8
  v_add_u32 v70, 32, v1
  v_max_i32 v71, 0, v70
  v_mul_u32_u24 v72, 3121, v71
  v_lshrrev_b32 v72, 16, v72
  v_mul_u32_u24 v73, 21, v72
  v_sub_u32 v73, v71, v73
  v_mul_u32_u24 v72, 2560, v72
  v_lshl_add_u32 v72, v73, 4, v72
  v_add_u32 v72, s48, v72
  v_cmp_eq_u32 vcc, 20, v73
  v_mov_b32 v74, 10240
  s_nop 0
  v_cndmask_b32 v72, v72, v74, vcc
  v_add_u32 v9, s45, v72
  v_subrev_u32 v9, 2048, v9
  s_waitcnt lgkmcnt(0)
  s_mov_b32 s8, s6
  s_mov_b32 s9, s7
  s_mov_b32 s6, 2621440
  s_mov_b32 s7, 0x20000
  s_mov_b32 s10, 2457600
  s_mov_b32 s11, 0x20000
  s_mov_b32 s12, s58
  s_mov_b32 s13, s59
  s_mov_b32 s14, 268435456
  s_mov_b32 s15, 0x20000
  s_lshl_b32 s45, s41, 3
  s_lshl_b32 s46, s42, 1
  s_add_u32 s45, s45, s46
  s_mul_i32 s45, s45, 123392
  s_add_u32 s45, s45, 0
  s_add_u32 s44, s45, s54
  s_add_u32 s46, s45, s55
  s_and_b32 s45, s40, 1
  s_lshl_b32 s45, s45, 3
  s_add_u32 s46, s46, s45
  v_lshlrev_b32 v68, 4, v1
  v_lshlrev_b32 v69, 4, v1
  v_mov_b32 v18, 0
  v_mov_b32 v19, 0
  v_mov_b32 v20, 0
  v_mov_b32 v21, 0
  s_add_u32 s45, s44, 123392
  buffer_load_dwordx4 v[10:13], v69, s[12:15], s44 offen
  buffer_load_dwordx4 v[14:17], v69, s[12:15], s45 offen
  s_add_u32 s45, s46, 123392
  s_mov_b32 exec_hi, 0
  buffer_load_dwordx2 v[18:19], v68, s[12:15], s46 offen
  buffer_load_dwordx2 v[20:21], v68, s[12:15], s45 offen
  s_mov_b32 exec_hi, -1
  s_mov_b32 s53, 0
  s_mov_b32 s45, s47
  s_lshl_b32 s46, s53, 3
  s_add_u32 s46, s46, s18
  s_mul_i32 s46, s46, 123392
  s_mov_b32 m0, s45
  s_add_u32 s46, s46, 0
  buffer_load_dwordx4 v119, s[12:15], s46 offen lds
  buffer_load_dwordx4 v8, s[12:15], s46 offen offset:1024 lds
  s_mov_b32 exec_hi, 1048575
  buffer_load_dwordx4 v9, s[12:15], s46 offen offset:2048 lds
  s_mov_b32 exec_hi, -1
  s_add_u32 s53, s53, 1
  s_and_b32 s53, s53, 7
  s_add_u32 s45, s45, 23040
  s_lshl_b32 s46, s53, 3
  s_add_u32 s46, s46, s18
  s_mul_i32 s46, s46, 123392
  s_mov_b32 m0, s45
  s_add_u32 s46, s46, 0
  buffer_load_dwordx4 v119, s[12:15], s46 offen lds
  buffer_load_dwordx4 v8, s[12:15], s46 offen offset:1024 lds
  s_mov_b32 exec_hi, 1048575
  buffer_load_dwordx4 v9, s[12:15], s46 offen offset:2048 lds
  s_mov_b32 exec_hi, -1
  s_add_u32 s53, s53, 1
  s_and_b32 s53, s53, 7
  s_or_b32 s61, s2, s18
  s_cmp_lg_u32 s61, 0
  s_cbranch_scc1 fk_nononce0
  s_memrealtime s[62:63]
  s_waitcnt lgkmcnt(0)
  s_or_b32 s60, s62, 1
  v_mov_b32 v124, 0
  v_mov_b32 v125, s60
  s_mov_b64 exec, 1
  global_store_dword v124, v125, s[56:57] sc0 sc1
  s_mov_b64 exec, -1
fk_nononce0:
  s_mul_i32 s44, s43, 17280
  v_lshlrev_b32 v116, 4, v1
  v_add_u32 v116, s44, v116
  v_and_b32 v68, 31, v1
  v_lshrrev_b32 v69, 5, v1
  v_lshlrev_b32 v117, 4, v68
  s_and_b32 s45, s40, 1
  s_lshl_b32 s45, s45, 3
  s_add_u32 s45, s45, 1024
  v_add_u32 v117, s45, v117
  v_cmp_eq_u32 vcc, 1, v69
  v_mov_b32 v70, 1856
  s_nop 0
  v_cndmask_b32 v117, v117, v70, vcc
  v_add_u32 v117, s44, v117
  v_min_u32 v70, 20, v68
  v_cmp_le_u32 vcc, 28, v68
  v_mul_u32_u24 v71, 21, v69
  s_nop 0
  v_cndmask_b32 v70, v70, 4, vcc
  v_add_u32 v70, v70, v71
  v_lshlrev_b32 v118, 4, v70
  v_add_u32 v118, s44, v118
  v_mov_b32 v72, 0
  v_mov_b32 v73, 70656
  ds_write_b32 v73, v72
fk_a_restart:
  v_mov_b32 v84, 0
  v_mov_b32 v85, 0
  v_mov_b32 v86, 0
  v_mov_b32 v87, 0
  v_mov_b32 v88, 0
  v_mov_b32 v89, 0
  v_mov_b32 v90, 0
  v_mov_b32 v91, 0
  v_mov_b32 v92, 0
  v_mov_b32 v93, 0
  v_mov_b32 v94, 0
  v_mov_b32 v95, 0
  v_mov_b32 v96, 0
  v_mov_b32 v97, 0
  v_mov_b32 v98, 0
  v_mov_b32 v99, 0
  v_mov_b32 v100, 0
  v_mov_b32 v101, 0
  v_mov_b32 v102, 0
  v_mov_b32 v103, 0
  v_mov_b32 v104, 0
  v_mov_b32 v105, 0
  v_mov_b32 v106, 0
  v_mov_b32 v107, 0
  v_mov_b32 v108, 0
  v_mov_b32 v109, 0
  v_mov_b32 v110, 0
  v_mov_b32 v111, 0
  v_mov_b32 v112, 0
  v_mov_b32 v113, 0
  v_mov_b32 v114, 0
  v_mov_b32 v115, 0
  v_mov_b32 v44, 0
  v_mov_b32 v45, 0
  v_mov_b32 v46, 0
  v_mov_b32 v47, 0
  v_mov_b32 v48, 0
  v_mov_b32 v49, 0
  v_mov_b32 v50, 0
  v_mov_b32 v51, 0
  v_mov_b32 v124, 0
  v_mov_b32 v120, 0
  v_mov_b32 v28, 0
  v_mov_b32 v32, 0
  v_mov_b32 v125, 0
  v_mov_b32 v121, 0
  v_mov_b32 v29, 0
  v_mov_b32 v33, 0
  v_mov_b32 v126, 0
  v_mov_b32 v122, 0
  v_mov_b32 v30, 0
  v_mov_b32 v34, 0
  v_mov_b32 v127, 0
  v_mov_b32 v123, 0
  v_mov_b32 v31, 0
  v_mov_b32 v35, 0
  s_mov_b32 s82, 0x1fffff
  s_mov_b32 s83, 0x1fffff
  s_mov_b32 s48, 0
  s_mov_b32 s50, 0
  s_mov_b32 s52, 46080
  s_waitcnt vmcnt(3) lgkmcnt(0)
  s_barrier
  ds_read_b128 v[22:25], v116 offset:0
  ds_read_b64 v[26:27], v117 offset:0
  ds_read_b128 v[2:5], v116 offset:2880
  ds_read_b64 v[6:7], v117 offset:2880
  s_mov_b64 exec, s[82:83]
  ds_read_b128 v[28:31], v118 offset:1536
  ds_read_b128 v[32:35], v118 offset:2208
  s_mov_b64 exec, -1
  s_waitcnt lgkmcnt(4)
  v_mfma_f32_32x32x16_bf16 v[52:67], v[22:25], v[10:13], 0
  v_mfma_f32_32x32x8_bf16 v[52:67], v[26:27], v[18:19], v[52:67]
  s_waitcnt lgkmcnt(0)
  s_nop 7
  s_nop 3
  s_setprio 1
  s_cmp_lg_u32 s43, 0
  s_cbranch_scc1 fk_a_grp1
.p2align 6
  s_nop 0
fk_a_loopa:
  v_mfma_f32_32x32x16_bf16 v[68:83], v[22:25], v[14:17], 0
  v_exp_f32 v52, v52
  v_exp_f32 v53, v53
  v_exp_f32 v54, v54
  v_exp_f32 v55, v55
  v_mfma_f32_32x32x8_bf16 v[68:83], v[26:27], v[20:21], v[68:83]
  ds_read_b128 v[22:25], v116 offset:5760
  ds_read_b64 v[26:27], v117 offset:5760
  v_exp_f32 v56, v56
  v_exp_f32 v57, v57
  v_exp_f32 v58, v58
  v_cvt_pk_bf16_f32 v36, v52, v53
  v_cvt_pk_bf16_f32 v37, v54, v55
  v_mfma_f32_32x32x16_bf16 v[100:115], v[124:127], v[44:47], v[100:115]
  v_exp_f32 v59, v59
  v_exp_f32 v60, v60
  v_exp_f32 v61, v61
  v_cvt_pk_bf16_f32 v38, v56, v57
  v_cvt_pk_bf16_f32 v39, v58, v59
  v_mfma_f32_32x32x16_bf16 v[100:115], v[120:123], v[48:51], v[100:115]
  s_mov_b64 exec, s[82:83]
  ds_read_b128 v[124:127], v118 offset:4416
  ds_read_b128 v[120:123], v118 offset:5088
  s_mov_b64 exec, -1
  v_exp_f32 v62, v62
  v_exp_f32 v63, v63
  v_cvt_pk_bf16_f32 v40, v60, v61
  v_exp_f32 v64, v64
  v_exp_f32 v65, v65
  v_cvt_pk_bf16_f32 v41, v62, v63
  v_exp_f32 v66, v66
  v_exp_f32 v67, v67
  s_nop 0
  v_cvt_pk_bf16_f32 v42, v64, v65
  v_cvt_pk_bf16_f32 v43, v66, v67
  s_waitcnt lgkmcnt(4)
  v_mfma_f32_32x32x16_bf16 v[52:67], v[2:5], v[10:13], 0
  v_exp_f32 v68, v68
  v_exp_f32 v69, v69
  v_exp_f32 v70, v70
  v_exp_f32 v71, v71
  v_mfma_f32_32x32x8_bf16 v[52:67], v[6:7], v[18:19], v[52:67]
  v_exp_f32 v72, v72
  v_exp_f32 v73, v73
  v_exp_f32 v74, v74
  v_cvt_pk_bf16_f32 v44, v68, v69
  v_cvt_pk_bf16_f32 v45, v70, v71
  v_mfma_f32_32x32x16_bf16 v[84:99], v[28:31], v[36:39], v[84:99]
  v_exp_f32 v75, v75
  v_exp_f32 v76, v76
  v_exp_f32 v77, v77
  v_cvt_pk_bf16_f32 v46, v72, v73
  v_cvt_pk_bf16_f32 v47, v74, v75
  v_mfma_f32_32x32x16_bf16 v[84:99], v[32:35], v[40:43], v[84:99]
  v_exp_f32 v78, v78
  v_exp_f32 v79, v79
  v_cvt_pk_bf16_f32 v48, v76, v77
  v_exp_f32 v80, v80
  v_exp_f32 v81, v81
  v_cvt_pk_bf16_f32 v49, v78, v79
  v_exp_f32 v82, v82
  v_exp_f32 v83, v83
  s_nop 0
  v_cvt_pk_bf16_f32 v50, v80, v81
  v_cvt_pk_bf16_f32 v51, v82, v83
  v_mfma_f32_32x32x16_bf16 v[68:83], v[2:5], v[14:17], 0
  v_exp_f32 v52, v52
  v_exp_f32 v53, v53
  v_exp_f32 v54, v54
  v_exp_f32 v55, v55
  v_mfma_f32_32x32x8_bf16 v[68:83], v[6:7], v[20:21], v[68:83]
  ds_read_b128 v[2:5], v116 offset:8640
  ds_read_b64 v[6:7], v117 offset:8640
  v_exp_f32 v56, v56
  v_exp_f32 v57, v57
  v_exp_f32 v58, v58
  v_cvt_pk_bf16_f32 v36, v52, v53
  v_cvt_pk_bf16_f32 v37, v54, v55
  v_mfma_f32_32x32x16_bf16 v[100:115], v[28:31], v[44:47], v[100:115]
  v_exp_f32 v59, v59
  v_exp_f32 v60, v60
  v_exp_f32 v61, v61
  v_cvt_pk_bf16_f32 v38, v56, v57
  v_cvt_pk_bf16_f32 v39, v58, v59
  v_mfma_f32_32x32x16_bf16 v[100:115], v[32:35], v[48:51], v[100:115]
  s_mov_b64 exec, s[82:83]
  ds_read_b128 v[28:31], v118 offset:7296
  ds_read_b128 v[32:35], v118 offset:7968
  s_mov_b64 exec, -1
  v_exp_f32 v62, v62
  v_exp_f32 v63, v63
  v_cvt_pk_bf16_f32 v40, v60, v61
  v_exp_f32 v64, v64
  v_exp_f32 v65, v65
  v_cvt_pk_bf16_f32 v41, v62, v63
  v_exp_f32 v66, v66
  v_exp_f32 v67, v67
  s_nop 0
  v_cvt_pk_bf16_f32 v42, v64, v65
  v_cvt_pk_bf16_f32 v43, v66, v67
  s_waitcnt lgkmcnt(4)
  v_mfma_f32_32x32x16_bf16 v[52:67], v[22:25], v[10:13], 0
  v_exp_f32 v68, v68
  v_exp_f32 v69, v69
  v_exp_f32 v70, v70
  v_exp_f32 v71, v71
  v_mfma_f32_32x32x8_bf16 v[52:67], v[26:27], v[18:19], v[52:67]
  v_exp_f32 v72, v72
  v_exp_f32 v73, v73
  v_exp_f32 v74, v74
  v_cvt_pk_bf16_f32 v44, v68, v69
  v_cvt_pk_bf16_f32 v45, v70, v71
  v_mfma_f32_32x32x16_bf16 v[84:99], v[124:127], v[36:39], v[84:99]
  v_exp_f32 v75, v75
  v_exp_f32 v76, v76
  v_exp_f32 v77, v77
  v_cvt_pk_bf16_f32 v46, v72, v73
  v_cvt_pk_bf16_f32 v47, v74, v75
  v_mfma_f32_32x32x16_bf16 v[84:99], v[120:123], v[40:43], v[84:99]
  v_exp_f32 v78, v78
  v_exp_f32 v79, v79
  v_cvt_pk_bf16_f32 v48, v76, v77
  v_exp_f32 v80, v80
  v_exp_f32 v81, v81
  v_cvt_pk_bf16_f32 v49, v78, v79
  v_exp_f32 v82, v82
  v_exp_f32 v83, v83
  s_nop 0
  v_cvt_pk_bf16_f32 v50, v80, v81
  v_cvt_pk_bf16_f32 v51, v82, v83
  v_mfma_f32_32x32x16_bf16 v[68:83], v[22:25], v[14:17], 0
  v_exp_f32 v52, v52
  v_exp_f32 v53, v53
  v_exp_f32 v54, v54
  v_exp_f32 v55, v55
  v_mfma_f32_32x32x8_bf16 v[68:83], v[26:27], v[20:21], v[68:83]
  ds_read_b128 v[22:25], v116 offset:11520
  ds_read_b64 v[26:27], v117 offset:11520
  v_exp_f32 v56, v56
  v_exp_f32 v57, v57
  v_exp_f32 v58, v58
  v_cvt_pk_bf16_f32 v36, v52, v53
  v_cvt_pk_bf16_f32 v37, v54, v55
  v_mfma_f32_32x32x16_bf16 v[100:115], v[124:127], v[44:47], v[100:115]
  v_exp_f32 v59, v59
  v_exp_f32 v60, v60
  v_exp_f32 v61, v61
  v_cvt_pk_bf16_f32 v38, v56, v57
  v_cvt_pk_bf16_f32 v39, v58, v59
  v_mfma_f32_32x32x16_bf16 v[100:115], v[120:123], v[48:51], v[100:115]
  s_mov_b64 exec, s[82:83]
  ds_read_b128 v[124:127], v118 offset:10176
  ds_read_b128 v[120:123], v118 offset:10848
  s_mov_b64 exec, -1
  v_exp_f32 v62, v62
  v_exp_f32 v63, v63
  v_cvt_pk_bf16_f32 v40, v60, v61
  v_exp_f32 v64, v64
  v_exp_f32 v65, v65
  v_cvt_pk_bf16_f32 v41, v62, v63
  v_exp_f32 v66, v66
  v_exp_f32 v67, v67
  s_nop 0
  v_cvt_pk_bf16_f32 v42, v64, v65
  v_cvt_pk_bf16_f32 v43, v66, v67
  s_waitcnt lgkmcnt(4)
  v_mfma_f32_32x32x16_bf16 v[52:67], v[2:5], v[10:13], 0
  v_exp_f32 v68, v68
  v_exp_f32 v69, v69
  v_exp_f32 v70, v70
  v_exp_f32 v71, v71
  v_mfma_f32_32x32x8_bf16 v[52:67], v[6:7], v[18:19], v[52:67]
  v_exp_f32 v72, v72
  v_exp_f32 v73, v73
  v_exp_f32 v74, v74
  v_cvt_pk_bf16_f32 v44, v68, v69
  v_cvt_pk_bf16_f32 v45, v70, v71
  v_mfma_f32_32x32x16_bf16 v[84:99], v[28:31], v[36:39], v[84:99]
  v_exp_f32 v75, v75
  v_exp_f32 v76, v76
  v_exp_f32 v77, v77
  v_cvt_pk_bf16_f32 v46, v72, v73
  v_cvt_pk_bf16_f32 v47, v74, v75
  v_mfma_f32_32x32x16_bf16 v[84:99], v[32:35], v[40:43], v[84:99]
  v_exp_f32 v78, v78
  v_exp_f32 v79, v79
  v_cvt_pk_bf16_f32 v48, v76, v77
  v_exp_f32 v80, v80
  v_exp_f32 v81, v81
  v_cvt_pk_bf16_f32 v49, v78, v79
  v_exp_f32 v82, v82
  v_exp_f32 v83, v83
  s_nop 0
  v_cvt_pk_bf16_f32 v50, v80, v81
  v_cvt_pk_bf16_f32 v51, v82, v83
  v_mfma_f32_32x32x16_bf16 v[68:83], v[2:5], v[14:17], 0
  v_exp_f32 v52, v52
  v_exp_f32 v53, v53
  v_exp_f32 v54, v54
  v_exp_f32 v55, v55
  v_mfma_f32_32x32x8_bf16 v[68:83], v[6:7], v[20:21], v[68:83]
  ds_read_b128 v[2:5], v116 offset:14400
  ds_read_b64 v[6:7], v117 offset:14400
  v_exp_f32 v56, v56
  v_exp_f32 v57, v57
  v_exp_f32 v58, v58
  v_cvt_pk_bf16_f32 v36, v52, v53
  v_cvt_pk_bf16_f32 v37, v54, v55
  v_mfma_f32_32x32x16_bf16 v[100:115], v[28:31], v[44:47], v[100:115]
  v_exp_f32 v59, v59
  v_exp_f32 v60, v60
  v_exp_f32 v61, v61
  v_cvt_pk_bf16_f32 v38, v56, v57
  v_cvt_pk_bf16_f32 v39, v58, v59
  v_mfma_f32_32x32x16_bf16 v[100:115], v[32:35], v[48:51], v[100:115]
  s_mov_b64 exec, s[82:83]
  ds_read_b128 v[28:31], v118 offset:13056
  ds_read_b128 v[32:35], v118 offset:13728
  s_mov_b64 exec, -1
  v_exp_f32 v62, v62
  v_exp_f32 v63, v63
  v_cvt_pk_bf16_f32 v40, v60, v61
  v_exp_f32 v64, v64
  v_exp_f32 v65, v65
  v_cvt_pk_bf16_f32 v41, v62, v63
  v_exp_f32 v66, v66
  v_exp_f32 v67, v67
  s_nop 0
  v_cvt_pk_bf16_f32 v42, v64, v65
  v_cvt_pk_bf16_f32 v43, v66, v67
  s_waitcnt lgkmcnt(4)
  v_mfma_f32_32x32x16_bf16 v[52:67], v[22:25], v[10:13], 0
  v_exp_f32 v68, v68
  v_exp_f32 v69, v69
  v_exp_f32 v70, v70
  v_exp_f32 v71, v71
  v_mfma_f32_32x32x8_bf16 v[52:67], v[26:27], v[18:19], v[52:67]
  v_exp_f32 v72, v72
  v_exp_f32 v73, v73
  v_exp_f32 v74, v74
  v_cvt_pk_bf16_f32 v44, v68, v69
  v_cvt_pk_bf16_f32 v45, v70, v71
  v_mfma_f32_32x32x16_bf16 v[84:99], v[124:127], v[36:39], v[84:99]
  v_exp_f32 v75, v75
  v_exp_f32 v76, v76
  v_exp_f32 v77, v77
  v_cvt_pk_bf16_f32 v46, v72, v73
  v_cvt_pk_bf16_f32 v47, v74, v75
  v_mfma_f32_32x32x16_bf16 v[84:99], v[120:123], v[40:43], v[84:99]
  v_exp_f32 v78, v78
  v_exp_f32 v79, v79
  v_cvt_pk_bf16_f32 v48, v76, v77
  v_exp_f32 v80, v80
  v_exp_f32 v81, v81
  v_cvt_pk_bf16_f32 v49, v78, v79
  v_exp_f32 v82, v82
  v_exp_f32 v83, v83
  s_nop 0
  v_cvt_pk_bf16_f32 v50, v80, v81
  v_cvt_pk_bf16_f32 v51, v82, v83
  v_mfma_f32_32x32x16_bf16 v[68:83], v[22:25], v[14:17], 0
  v_exp_f32 v52, v52
  v_exp_f32 v53, v53
  v_exp_f32 v54, v54
  v_exp_f32 v55, v55
  v_mfma_f32_32x32x8_bf16 v[68:83], v[26:27], v[20:21], v[68:83]
  s_waitcnt vmcnt(0)
  s_barrier
  s_cmp_gt_u32 s48, 1
  s_cbranch_scc1 fk_ah0
  s_cmp_eq_u32 s48, 1
  s_cbranch_scc1 fk_ah10
  v_mov_b32 v0, 0
  global_load_dword v0, v0, s[56:57] sc0 sc1
  s_branch fk_ah0
fk_ah10:
  s_cmp_lg_u32 s60, 0
  s_cbranch_scc1 fk_ah0
  v_readfirstlane_b32 s60, v0
fk_ah0:
  s_add_u32 s50, s50, 23040
  s_cmp_ge_u32 s50, 69120
  s_cselect_b32 s50, 0, s50
  s_mov_b32 s49, 23040
  s_cmov_b32 s49, -46080
  v_add_u32 v116, s49, v116
  v_add_u32 v117, s49, v117
  s_cmp_ge_u32 s48, 6
  s_cbranch_scc1 fk_a_nodma0
  s_cmp_lg_u32 s43, 0
  s_cbranch_scc1 fk_a_nodma0
  s_add_u32 s45, s52, s47
  s_lshl_b32 s46, s53, 3
  s_add_u32 s46, s46, s18
  s_mul_i32 s46, s46, 123392
  s_mov_b32 m0, s45
  s_add_u32 s46, s46, 0
  buffer_load_dwordx4 v119, s[12:15], s46 offen lds
  buffer_load_dwordx4 v8, s[12:15], s46 offen offset:1024 lds
  s_mov_b32 exec_hi, 1048575
  buffer_load_dwordx4 v9, s[12:15], s46 offen offset:2048 lds
  s_mov_b32 exec_hi, -1
  s_add_u32 s46, s46, 493568
  s_add_u32 m0, s45, 11520
  s_nop 0
  buffer_load_dwordx4 v119, s[12:15], s46 offen lds
  buffer_load_dwordx4 v8, s[12:15], s46 offen offset:1024 lds
  s_mov_b32 exec_hi, 1048575
  buffer_load_dwordx4 v9, s[12:15], s46 offen offset:2048 lds
  s_mov_b32 exec_hi, -1
  s_add_u32 s53, s53, 1
  s_and_b32 s53, s53, 7
  s_add_u32 s52, s52, 23040
  s_cmp_ge_u32 s52, 69120
  s_cselect_b32 s52, 0, s52
fk_a_nodma0:
  ds_read_b128 v[22:25], v116 offset:0
  ds_read_b64 v[26:27], v117 offset:0
  v_exp_f32 v56, v56
  v_exp_f32 v57, v57
  v_exp_f32 v58, v58
  v_cvt_pk_bf16_f32 v36, v52, v53
  v_cvt_pk_bf16_f32 v37, v54, v55
  v_mfma_f32_32x32x16_bf16 v[100:115], v[124:127], v[44:47], v[100:115]
  v_exp_f32 v59, v59
  v_exp_f32 v60, v60
  v_exp_f32 v61, v61
  v_cvt_pk_bf16_f32 v38, v56, v57
  v_cvt_pk_bf16_f32 v39, v58, v59
  v_mfma_f32_32x32x16_bf16 v[100:115], v[120:123], v[48:51], v[100:115]
  s_mov_b64 exec, s[82:83]
  ds_read_b128 v[124:127], v118 offset:15936
  ds_read_b128 v[120:123], v118 offset:16608
  s_mov_b64 exec, -1
  v_exp_f32 v62, v62
  v_exp_f32 v63, v63
  v_cvt_pk_bf16_f32 v40, v60, v61
  v_exp_f32 v64, v64
  v_exp_f32 v65, v65
  v_cvt_pk_bf16_f32 v41, v62, v63
  v_exp_f32 v66, v66
  v_exp_f32 v67, v67
  s_nop 0
  v_cvt_pk_bf16_f32 v42, v64, v65
  v_cvt_pk_bf16_f32 v43, v66, v67
  s_waitcnt lgkmcnt(4)
  v_mfma_f32_32x32x16_bf16 v[52:67], v[2:5], v[10:13], 0
  v_exp_f32 v68, v68
  v_exp_f32 v69, v69
  v_exp_f32 v70, v70
  v_exp_f32 v71, v71
  v_mfma_f32_32x32x8_bf16 v[52:67], v[6:7], v[18:19], v[52:67]
  v_exp_f32 v72, v72
  v_exp_f32 v73, v73
  v_exp_f32 v74, v74
  v_cvt_pk_bf16_f32 v44, v68, v69
  v_cvt_pk_bf16_f32 v45, v70, v71
  v_mfma_f32_32x32x16_bf16 v[84:99], v[28:31], v[36:39], v[84:99]
  v_exp_f32 v75, v75
  v_exp_f32 v76, v76
  v_exp_f32 v77, v77
  v_cvt_pk_bf16_f32 v46, v72, v73
  v_cvt_pk_bf16_f32 v47, v74, v75
  v_mfma_f32_32x32x16_bf16 v[84:99], v[32:35], v[40:43], v[84:99]
  v_exp_f32 v78, v78
  v_exp_f32 v79, v79
  v_cvt_pk_bf16_f32 v48, v76, v77
  v_exp_f32 v80, v80
  v_exp_f32 v81, v81
  v_cvt_pk_bf16_f32 v49, v78, v79
  v_exp_f32 v82, v82
  v_exp_f32 v83, v83
  s_nop 0
  v_cvt_pk_bf16_f32 v50, v80, v81
  v_cvt_pk_bf16_f32 v51, v82, v83
  v_mfma_f32_32x32x16_bf16 v[68:83], v[2:5], v[14:17], 0
  v_exp_f32 v52, v52
  v_exp_f32 v53, v53
  v_exp_f32 v54, v54
  v_exp_f32 v55, v55
  v_mfma_f32_32x32x8_bf16 v[68:83], v[6:7], v[20:21], v[68:83]
  ds_read_b128 v[2:5], v116 offset:2880
  ds_read_b64 v[6:7], v117 offset:2880
  v_exp_f32 v56, v56
  v_exp_f32 v57, v57
  v_exp_f32 v58, v58
  v_cvt_pk_bf16_f32 v36, v52, v53
  v_cvt_pk_bf16_f32 v37, v54, v55
  v_mfma_f32_32x32x16_bf16 v[100:115], v[28:31], v[44:47], v[100:115]
  v_exp_f32 v59, v59
  v_exp_f32 v60, v60
  v_exp_f32 v61, v61
  v_cvt_pk_bf16_f32 v38, v56, v57
  v_cvt_pk_bf16_f32 v39, v58, v59
  v_mfma_f32_32x32x16_bf16 v[100:115], v[32:35], v[48:51], v[100:115]
  v_add_u32 v118, s49, v118
  s_mov_b64 exec, s[82:83]
  ds_read_b128 v[28:31], v118 offset:1536
  ds_read_b128 v[32:35], v118 offset:2208
  s_mov_b64 exec, -1
  v_exp_f32 v62, v62
  v_exp_f32 v63, v63
  v_cvt_pk_bf16_f32 v40, v60, v61
  v_exp_f32 v64, v64
  v_exp_f32 v65, v65
  v_cvt_pk_bf16_f32 v41, v62, v63
  v_exp_f32 v66, v66
  v_exp_f32 v67, v67
  s_nop 0
  v_cvt_pk_bf16_f32 v42, v64, v65
  v_cvt_pk_bf16_f32 v43, v66, v67
  s_waitcnt lgkmcnt(4)
  v_mfma_f32_32x32x16_bf16 v[52:67], v[22:25], v[10:13], 0
  v_exp_f32 v68, v68
  v_exp_f32 v69, v69
  v_exp_f32 v70, v70
  v_exp_f32 v71, v71
  v_mfma_f32_32x32x8_bf16 v[52:67], v[26:27], v[18:19], v[52:67]
  v_exp_f32 v72, v72
  v_exp_f32 v73, v73
  v_exp_f32 v74, v74
  v_cvt_pk_bf16_f32 v44, v68, v69
  v_cvt_pk_bf16_f32 v45, v70, v71
  v_mfma_f32_32x32x16_bf16 v[84:99], v[124:127], v[36:39], v[84:99]
  v_exp_f32 v75, v75
  v_exp_f32 v76, v76
  v_exp_f32 v77, v77
  v_cvt_pk_bf16_f32 v46, v72, v73
  v_cvt_pk_bf16_f32 v47, v74, v75
  v_mfma_f32_32x32x16_bf16 v[84:99], v[120:123], v[40:43], v[84:99]
  v_exp_f32 v78, v78
  v_exp_f32 v79, v79
  v_cvt_pk_bf16_f32 v48, v76, v77
  v_exp_f32 v80, v80
  v_exp_f32 v81, v81
  v_cvt_pk_bf16_f32 v49, v78, v79
  v_exp_f32 v82, v82
  v_exp_f32 v83, v83
  s_nop 0
  v_cvt_pk_bf16_f32 v50, v80, v81
  v_cvt_pk_bf16_f32 v51, v82, v83
  s_add_u32 s48, s48, 1
  s_cmp_lt_u32 s48, 8
  s_cbranch_scc1 fk_a_loopa
  s_branch fk_a_loopend
fk_a_grp1:
.p2align 6
  s_nop 0
fk_a_loopb:
  v_mfma_f32_32x32x16_bf16 v[68:83], v[22:25], v[14:17], 0
  v_exp_f32 v52, v52
  v_exp_f32 v53, v53
  v_exp_f32 v54, v54
  v_exp_f32 v55, v55
  v_mfma_f32_32x32x8_bf16 v[68:83], v[26:27], v[20:21], v[68:83]
  s_waitcnt vmcnt(0)
  s_barrier
  s_cmp_gt_u32 s48, 1
  s_cbranch_scc1 fk_ah1
  s_cmp_eq_u32 s48, 1
  s_cbranch_scc1 fk_ah11
  v_mov_b32 v0, 0
  global_load_dword v0, v0, s[56:57] sc0 sc1
  s_branch fk_ah1
fk_ah11:
  s_cmp_lg_u32 s60, 0
  s_cbranch_scc1 fk_ah1
  v_readfirstlane_b32 s60, v0
fk_ah1:
  s_add_u32 s50, s50, 23040
  s_cmp_ge_u32 s50, 69120
  s_cselect_b32 s50, 0, s50
  s_mov_b32 s49, 23040
  s_cmov_b32 s49, -46080
  v_add_u32 v116, s49, v116
  v_add_u32 v117, s49, v117
  ds_read_b128 v[22:25], v116 offset:0
  ds_read_b64 v[26:27], v117 offset:0
  v_exp_f32 v56, v56
  v_exp_f32 v57, v57
  v_exp_f32 v58, v58
  v_cvt_pk_bf16_f32 v36, v52, v53
  v_cvt_pk_bf16_f32 v37, v54, v55
  v_mfma_f32_32x32x16_bf16 v[100:115], v[124:127], v[44:47], v[100:115]
  v_exp_f32 v59, v59
  v_exp_f32 v60, v60
  v_exp_f32 v61, v61
  v_cvt_pk_bf16_f32 v38, v56, v57
  v_cvt_pk_bf16_f32 v39, v58, v59
  v_mfma_f32_32x32x16_bf16 v[100:115], v[120:123], v[48:51], v[100:115]
  s_mov_b64 exec, s[82:83]
  ds_read_b128 v[124:127], v118 offset:4416
  ds_read_b128 v[120:123], v118 offset:5088
  s_mov_b64 exec, -1
  v_exp_f32 v62, v62
  v_exp_f32 v63, v63
  v_cvt_pk_bf16_f32 v40, v60, v61
  v_exp_f32 v64, v64
  v_exp_f32 v65, v65
  v_cvt_pk_bf16_f32 v41, v62, v63
  v_exp_f32 v66, v66
  v_exp_f32 v67, v67
  s_nop 0
  v_cvt_pk_bf16_f32 v42, v64, v65
  v_cvt_pk_bf16_f32 v43, v66, v67
  s_waitcnt lgkmcnt(4)
  v_mfma_f32_32x32x16_bf16 v[52:67], v[2:5], v[10:13], 0
  v_exp_f32 v68, v68
  v_exp_f32 v69, v69
  v_exp_f32 v70, v70
  v_exp_f32 v71, v71
  v_mfma_f32_32x32x8_bf16 v[52:67], v[6:7], v[18:19], v[52:67]
  v_exp_f32 v72, v72
  v_exp_f32 v73, v73
  v_exp_f32 v74, v74
  v_cvt_pk_bf16_f32 v44, v68, v69
  v_cvt_pk_bf16_f32 v45, v70, v71
  v_mfma_f32_32x32x16_bf16 v[84:99], v[28:31], v[36:39], v[84:99]
  v_exp_f32 v75, v75
  v_exp_f32 v76, v76
  v_exp_f32 v77, v77
  v_cvt_pk_bf16_f32 v46, v72, v73
  v_cvt_pk_bf16_f32 v47, v74, v75
  v_mfma_f32_32x32x16_bf16 v[84:99], v[32:35], v[40:43], v[84:99]
  v_exp_f32 v78, v78
  v_exp_f32 v79, v79
  v_cvt_pk_bf16_f32 v48, v76, v77
  v_exp_f32 v80, v80
  v_exp_f32 v81, v81
  v_cvt_pk_bf16_f32 v49, v78, v79
  v_exp_f32 v82, v82
  v_exp_f32 v83, v83
  s_nop 0
  v_cvt_pk_bf16_f32 v50, v80, v81
  v_cvt_pk_bf16_f32 v51, v82, v83
  v_mfma_f32_32x32x16_bf16 v[68:83], v[2:5], v[14:17], 0
  v_exp_f32 v52, v52
  v_exp_f32 v53, v53
  v_exp_f32 v54, v54
  v_exp_f32 v55, v55
  v_mfma_f32_32x32x8_bf16 v[68:83], v[6:7], v[20:21], v[68:83]
  ds_read_b128 v[2:5], v116 offset:2880
  ds_read_b64 v[6:7], v117 offset:2880
  v_exp_f32 v56, v56
  v_exp_f32 v57, v57
  v_exp_f32 v58, v58
  v_cvt_pk_bf16_f32 v36, v52, v53
  v_cvt_pk_bf16_f32 v37, v54, v55
  v_mfma_f32_32x32x16_bf16 v[100:115], v[28:31], v[44:47], v[100:115]
  v_exp_f32 v59, v59
  v_exp_f32 v60, v60
  v_exp_f32 v61, v61
  v_cvt_pk_bf16_f32 v38, v56, v57
  v_cvt_pk_bf16_f32 v39, v58, v59
  v_mfma_f32_32x32x16_bf16 v[100:115], v[32:35], v[48:51], v[100:115]
  v_add_u32 v118, s49, v118
  s_mov_b64 exec, s[82:83]
  ds_read_b128 v[28:31], v118 offset:1536
  ds_read_b128 v[32:35], v118 offset:2208
  s_mov_b64 exec, -1
  v_exp_f32 v62, v62
  v_exp_f32 v63, v63
  v_cvt_pk_bf16_f32 v40, v60, v61
  v_exp_f32 v64, v64
  v_exp_f32 v65, v65
  v_cvt_pk_bf16_f32 v41, v62, v63
  v_exp_f32 v66, v66
  v_exp_f32 v67, v67
  s_nop 0
  v_cvt_pk_bf16_f32 v42, v64, v65
  v_cvt_pk_bf16_f32 v43, v66, v67
  s_waitcnt lgkmcnt(4)
  v_mfma_f32_32x32x16_bf16 v[52:67], v[22:25], v[10:13], 0
  v_exp_f32 v68, v68
  v_exp_f32 v69, v69
  v_exp_f32 v70, v70
  v_exp_f32 v71, v71
  v_mfma_f32_32x32x8_bf16 v[52:67], v[26:27], v[18:19], v[52:67]
  v_exp_f32 v72, v72
  v_exp_f32 v73, v73
  v_exp_f32 v74, v74
  v_cvt_pk_bf16_f32 v44, v68, v69
  v_cvt_pk_bf16_f32 v45, v70, v71
  v_mfma_f32_32x32x16_bf16 v[84:99], v[124:127], v[36:39], v[84:99]
  v_exp_f32 v75, v75
  v_exp_f32 v76, v76
  v_exp_f32 v77, v77
  v_cvt_pk_bf16_f32 v46, v72, v73
  v_cvt_pk_bf16_f32 v47, v74, v75
  v_mfma_f32_32x32x16_bf16 v[84:99], v[120:123], v[40:43], v[84:99]
  v_exp_f32 v78, v78
  v_exp_f32 v79, v79
  v_cvt_pk_bf16_f32 v48, v76, v77
  v_exp_f32 v80, v80
  v_exp_f32 v81, v81
  v_cvt_pk_bf16_f32 v49, v78, v79
  v_exp_f32 v82, v82
  v_exp_f32 v83, v83
  s_nop 0
  v_cvt_pk_bf16_f32 v50, v80, v81
  v_cvt_pk_bf16_f32 v51, v82, v83
  s_add_u32 s48, s48, 1
  s_cmp_lt_u32 s48, 8
  s_cbranch_scc1 fk_a_loopb
fk_a_loopend:
  s_nop 1
  v_mfma_f32_32x32x16_bf16 v[100:115], v[124:127], v[44:47], v[100:115]
  v_mfma_f32_32x32x16_bf16 v[100:115], v[120:123], v[48:51], v[100:115]
  s_waitcnt lgkmcnt(0)
  s_setprio 3
  s_mul_i32 s44, s18, 3072
  s_add_u32 s44, s44, 46080
  v_lshlrev_b32 v68, 4, v1
  v_add_u32 v69, s44, v68
  s_xor_b32 s45, s18, 4
  s_mul_i32 s45, s45, 3072
  s_add_u32 s45, s45, 46080
  v_add_u32 v70, s45, v68
  s_nop 3
  s_cmp_eq_u32 s43, 0
  s_cbranch_scc1 fk_a_kh0
  ds_write_b128 v69, v[84:87] offset:0
  ds_write_b128 v69, v[88:91] offset:1024
  ds_write_b128 v69, v[92:95] offset:2048
  v_mov_b32 v84, v100
  v_mov_b32 v85, v101
  v_mov_b32 v86, v102
  v_mov_b32 v87, v103
  v_mov_b32 v88, v104
  v_mov_b32 v89, v105
  v_mov_b32 v90, v106
  v_mov_b32 v91, v107
  v_mov_b32 v92, v108
  v_mov_b32 v93, v109
  v_mov_b32 v94, v110
  v_mov_b32 v95, v111
  s_branch fk_a_sent
fk_a_kh0:
  s_nop 7
  ds_write_b128 v69, v[100:103] offset:0
  ds_write_b128 v69, v[104:107] offset:1024
  ds_write_b128 v69, v[108:111] offset:2048
fk_a_sent:
  s_waitcnt lgkmcnt(0)
  s_barrier
  ds_read_b128 v[52:55], v70 offset:0
  ds_read_b128 v[56:59], v70 offset:1024
  ds_read_b128 v[60:63], v70 offset:2048
  v_and_b32 v68, 31, v1
  v_mul_u32_u24 v68, 48, v68
  v_lshrrev_b32 v69, 5, v1
  v_lshl_add_u32 v68, v69, 3, v68
  s_lshl_b32 s44, s18, 11
  s_add_u32 s44, s44, 24576
  v_add_u32 v68, s44, v68
  v_lshlrev_b32 v70, 4, v1
  v_add_u32 v69, s44, v70
  s_lshl_b32 s44, s41, 8
  s_lshl_b32 s45, s42, 6
  s_add_u32 s44, s44, s45
  s_lshl_b32 s45, s43, 5
  s_add_u32 s44, s44, s45
  s_mul_i32 s44, s44, 48
  s_mul_i32 s45, s40, 98304
  s_add_u32 s44, s44, s45
  s_add_u32 s44, s44, 14680064
  s_waitcnt lgkmcnt(0)
  v_add_f32 v84, v84, v52
  v_add_f32 v85, v85, v53
  v_add_f32 v86, v86, v54
  v_add_f32 v87, v87, v55
  v_add_f32 v88, v88, v56
  v_add_f32 v89, v89, v57
  v_add_f32 v90, v90, v58
  v_add_f32 v91, v91, v59
  v_add_f32 v92, v92, v60
  v_add_f32 v93, v93, v61
  v_add_f32 v94, v94, v62
  v_add_f32 v95, v95, v63
  v_mov_b32 v71, v92
  v_mov_b32 v72, v92
  s_nop 1
  v_permlane32_swap_b32 v71, v72
  s_nop 1
  v_rcp_f32 v73, v72
  v_mov_b32 v74, 0
  v_mul_f32 v84, v84, v73
  v_mul_f32 v85, v85, v73
  v_mul_f32 v86, v86, v73
  v_mul_f32 v87, v87, v73
  v_mul_f32 v88, v88, v73
  v_mul_f32 v89, v89, v73
  v_mul_f32 v90, v90, v73
  v_mul_f32 v91, v91, v73
  v_mul_f32 v92, v92, v73
  v_mul_f32 v93, v93, v73
  v_mul_f32 v94, v94, v73
  v_mul_f32 v95, v95, v73
  v_fma_f32 v74, v84, 0, v74
  v_fma_f32 v74, v85, 0, v74
  v_fma_f32 v74, v86, 0, v74
  v_fma_f32 v74, v87, 0, v74
  v_fma_f32 v74, v88, 0, v74
  v_fma_f32 v74, v89, 0, v74
  v_fma_f32 v74, v90, 0, v74
  v_fma_f32 v74, v91, 0, v74
  v_fma_f32 v74, v92, 0, v74
  v_fma_f32 v74, v93, 0, v74
  v_fma_f32 v74, v94, 0, v74
  v_fma_f32 v74, v95, 0, v74
  s_mov_b32 exec_lo, 0
  v_mov_b32 v92, 0
  v_mov_b32 v93, 0
  v_mov_b32 v94, 0
  v_mov_b32 v95, 0
  s_mov_b32 exec_lo, -1
  v_cvt_pk_bf16_f32 v52, v84, v85
  v_cvt_pk_bf16_f32 v53, v86, v87
  v_cvt_pk_bf16_f32 v54, v88, v89
  v_cvt_pk_bf16_f32 v55, v90, v91
  v_cvt_pk_bf16_f32 v56, v92, v93
  v_cvt_pk_bf16_f32 v57, v94, v95
  ds_write_b64 v68, v[52:53]
  ds_write_b64 v68, v[54:55] offset:16
  ds_write_b64 v68, v[56:57] offset:32
  v_cmp_o_f32 vcc, v74, v74
  s_mov_b32 s45, 0x21800000
  v_cmp_lt_f32 s[92:93], s45, v72
  s_mov_b32 s45, 0x5d800000
  v_cmp_gt_f32 s[94:95], s45, v72
  s_waitcnt lgkmcnt(0)
  ds_read_b128 v[60:63], v69
  ds_read_b128 v[64:67], v69 offset:1024
  s_and_b64 vcc, vcc, s[92:93]
  s_and_b64 vcc, vcc, s[94:95]
  s_cmp_eq_u64 vcc, -1
  s_cbranch_scc1 fk_a_ok
  v_mov_b32 v74, 1
  v_mov_b32 v75, 70656
  ds_write_b32 v75, v74
fk_a_ok:
  s_waitcnt lgkmcnt(0)
  buffer_store_dwordx4 v[60:63], v70, s[12:15], s44 offen sc1
  s_mov_b32 exec_hi, 0
  buffer_store_dwordx4 v[64:67], v70, s[12:15], s44 offen offset:1024 sc1
  s_mov_b32 exec_hi, -1
  v_mov_b32 v75, 70656
  s_waitcnt vmcnt(0)
  s_barrier
  ds_read_b32 v74, v75
  s_waitcnt lgkmcnt(0)
  v_readfirstlane_b32 s46, v74
  s_xor_b32 s45, s51, 1
  s_nop 2
  s_and_b32 s46, s46, s45
  s_cmp_lg_u32 s46, 0
  s_cbranch_scc1 fk_a_fallback
  s_cmp_lg_u32 s18, 0
  s_cbranch_scc1 fk_ap2
  s_lshl_b32 s62, s41, 5
  s_add_u32 s62, s62, s40
  s_lshl_b32 s62, s62, 7
  s_add_u32 s62, s62, 20021248
  s_cmp_lg_u32 s60, 0
  s_cbranch_scc1 fk_gn_done3
  s_mov_b32 s61, 0
  v_mov_b32 v124, 0
fk_gn_loop3:
  global_load_dword v125, v124, s[56:57] sc0 sc1
  s_add_u32 s61, s61, 1
  s_waitcnt vmcnt(0)
  v_readfirstlane_b32 s60, v125
  s_cmp_gt_u32 s61, 0x20000
  s_cbranch_scc1 fk_exit
  s_cmp_eq_u32 s60, 0
  s_cbranch_scc1 fk_gn_loop3
fk_gn_done3:
  v_lshlrev_b32 v123, 4, v1
  v_mov_b32 v124, s60
  v_mov_b32 v125, s60
  v_mov_b32 v126, s60
  v_mov_b32 v127, s60
  s_mov_b64 exec, 0xff
  buffer_store_dwordx4 v[124:127], v123, s[12:15], s62 offen sc0 sc1
  s_mov_b64 exec, -1
fk_ap2:
  s_branch fk_a_att_done
fk_a_fallback:
  s_mov_b32 s51, 1
  v_subrev_u32 v116, 46080, v116
  v_subrev_u32 v117, 46080, v117
  v_subrev_u32 v118, 46080, v118
  s_barrier
  s_mov_b32 s53, 0
  s_mov_b32 s45, s47
  s_lshl_b32 s46, s53, 3
  s_add_u32 s46, s46, s18
  s_mul_i32 s46, s46, 123392
  s_mov_b32 m0, s45
  s_add_u32 s46, s46, 0
  buffer_load_dwordx4 v119, s[12:15], s46 offen lds
  buffer_load_dwordx4 v8, s[12:15], s46 offen offset:1024 lds
  s_mov_b32 exec_hi, 1048575
  buffer_load_dwordx4 v9, s[12:15], s46 offen offset:2048 lds
  s_mov_b32 exec_hi, -1
  s_add_u32 s53, s53, 1
  s_and_b32 s53, s53, 7
  s_add_u32 s45, s45, 23040
  s_lshl_b32 s46, s53, 3
  s_add_u32 s46, s46, s18
  s_mul_i32 s46, s46, 123392
  s_mov_b32 m0, s45
  s_add_u32 s46, s46, 0
  buffer_load_dwordx4 v119, s[12:15], s46 offen lds
  buffer_load_dwordx4 v8, s[12:15], s46 offen offset:1024 lds
  s_mov_b32 exec_hi, 1048575
  buffer_load_dwordx4 v9, s[12:15], s46 offen offset:2048 lds
  s_mov_b32 exec_hi, -1
  s_add_u32 s53, s53, 1
  s_and_b32 s53, s53, 7
  v_mov_b32 v36, 0xff800000
  v_mov_b32 v37, 0xff800000
  s_mov_b32 s48, 0
  s_mov_b32 s50, 0
  s_mov_b32 s52, 46080
  s_waitcnt vmcnt(3)
  s_barrier
  s_cmp_lg_u32 s43, 0
  s_cbranch_scc1 fk_a_mgrp1
fk_a_mxloopa:
  ds_read_b128 v[22:25], v116 offset:0
  ds_read_b64 v[26:27], v117 offset:0
  s_waitcnt lgkmcnt(0)
  v_mfma_f32_32x32x16_bf16 v[52:67], v[22:25], v[10:13], 0
  v_mfma_f32_32x32x8_bf16 v[52:67], v[26:27], v[18:19], v[52:67]
  v_mfma_f32_32x32x16_bf16 v[68:83], v[22:25], v[14:17], 0
  v_mfma_f32_32x32x8_bf16 v[68:83], v[26:27], v[20:21], v[68:83]
  s_nop 15
  s_nop 7
  v_max3_f32 v36, v36, v52, v53
  v_max3_f32 v36, v36, v54, v55
  v_max3_f32 v36, v36, v56, v57
  v_max3_f32 v36, v36, v58, v59
  v_max3_f32 v36, v36, v60, v61
  v_max3_f32 v36, v36, v62, v63
  v_max3_f32 v36, v36, v64, v65
  v_max3_f32 v36, v36, v66, v67
  v_max3_f32 v37, v37, v68, v69
  v_max3_f32 v37, v37, v70, v71
  v_max3_f32 v37, v37, v72, v73
  v_max3_f32 v37, v37, v74, v75
  v_max3_f32 v37, v37, v76, v77
  v_max3_f32 v37, v37, v78, v79
  v_max3_f32 v37, v37, v80, v81
  v_max3_f32 v37, v37, v82, v83
  ds_read_b128 v[22:25], v116 offset:2880
  ds_read_b64 v[26:27], v117 offset:2880
  s_waitcnt lgkmcnt(0)
  v_mfma_f32_32x32x16_bf16 v[52:67], v[22:25], v[10:13], 0
  v_mfma_f32_32x32x8_bf16 v[52:67], v[26:27], v[18:19], v[52:67]
  v_mfma_f32_32x32x16_bf16 v[68:83], v[22:25], v[14:17], 0
  v_mfma_f32_32x32x8_bf16 v[68:83], v[26:27], v[20:21], v[68:83]
  s_nop 15
  s_nop 7
  v_max3_f32 v36, v36, v52, v53
  v_max3_f32 v36, v36, v54, v55
  v_max3_f32 v36, v36, v56, v57
  v_max3_f32 v36, v36, v58, v59
  v_max3_f32 v36, v36, v60, v61
  v_max3_f32 v36, v36, v62, v63
  v_max3_f32 v36, v36, v64, v65
  v_max3_f32 v36, v36, v66, v67
  v_max3_f32 v37, v37, v68, v69
  v_max3_f32 v37, v37, v70, v71
  v_max3_f32 v37, v37, v72, v73
  v_max3_f32 v37, v37, v74, v75
  v_max3_f32 v37, v37, v76, v77
  v_max3_f32 v37, v37, v78, v79
  v_max3_f32 v37, v37, v80, v81
  v_max3_f32 v37, v37, v82, v83
  ds_read_b128 v[22:25], v116 offset:5760
  ds_read_b64 v[26:27], v117 offset:5760
  s_waitcnt lgkmcnt(0)
  v_mfma_f32_32x32x16_bf16 v[52:67], v[22:25], v[10:13], 0
  v_mfma_f32_32x32x8_bf16 v[52:67], v[26:27], v[18:19], v[52:67]
  v_mfma_f32_32x32x16_bf16 v[68:83], v[22:25], v[14:17], 0
  v_mfma_f32_32x32x8_bf16 v[68:83], v[26:27], v[20:21], v[68:83]
  s_nop 15
  s_nop 7
  v_max3_f32 v36, v36, v52, v53
  v_max3_f32 v36, v36, v54, v55
  v_max3_f32 v36, v36, v56, v57
  v_max3_f32 v36, v36, v58, v59
  v_max3_f32 v36, v36, v60, v61
  v_max3_f32 v36, v36, v62, v63
  v_max3_f32 v36, v36, v64, v65
  v_max3_f32 v36, v36, v66, v67
  v_max3_f32 v37, v37, v68, v69
  v_max3_f32 v37, v37, v70, v71
  v_max3_f32 v37, v37, v72, v73
  v_max3_f32 v37, v37, v74, v75
  v_max3_f32 v37, v37, v76, v77
  v_max3_f32 v37, v37, v78, v79
  v_max3_f32 v37, v37, v80, v81
  v_max3_f32 v37, v37, v82, v83
  ds_read_b128 v[22:25], v116 offset:8640
  ds_read_b64 v[26:27], v117 offset:8640
  s_waitcnt lgkmcnt(0)
  v_mfma_f32_32x32x16_bf16 v[52:67], v[22:25], v[10:13], 0
  v_mfma_f32_32x32x8_bf16 v[52:67], v[26:27], v[18:19], v[52:67]
  v_mfma_f32_32x32x16_bf16 v[68:83], v[22:25], v[14:17], 0
  v_mfma_f32_32x32x8_bf16 v[68:83], v[26:27], v[20:21], v[68:83]
  s_nop 15
  s_nop 7
  v_max3_f32 v36, v36, v52, v53
  v_max3_f32 v36, v36, v54, v55
  v_max3_f32 v36, v36, v56, v57
  v_max3_f32 v36, v36, v58, v59
  v_max3_f32 v36, v36, v60, v61
  v_max3_f32 v36, v36, v62, v63
  v_max3_f32 v36, v36, v64, v65
  v_max3_f32 v36, v36, v66, v67
  v_max3_f32 v37, v37, v68, v69
  v_max3_f32 v37, v37, v70, v71
  v_max3_f32 v37, v37, v72, v73
  v_max3_f32 v37, v37, v74, v75
  v_max3_f32 v37, v37, v76, v77
  v_max3_f32 v37, v37, v78, v79
  v_max3_f32 v37, v37, v80, v81
  v_max3_f32 v37, v37, v82, v83
  ds_read_b128 v[22:25], v116 offset:11520
  ds_read_b64 v[26:27], v117 offset:11520
  s_waitcnt lgkmcnt(0)
  v_mfma_f32_32x32x16_bf16 v[52:67], v[22:25], v[10:13], 0
  v_mfma_f32_32x32x8_bf16 v[52:67], v[26:27], v[18:19], v[52:67]
  v_mfma_f32_32x32x16_bf16 v[68:83], v[22:25], v[14:17], 0
  v_mfma_f32_32x32x8_bf16 v[68:83], v[26:27], v[20:21], v[68:83]
  s_nop 15
  s_nop 7
  v_max3_f32 v36, v36, v52, v53
  v_max3_f32 v36, v36, v54, v55
  v_max3_f32 v36, v36, v56, v57
  v_max3_f32 v36, v36, v58, v59
  v_max3_f32 v36, v36, v60, v61
  v_max3_f32 v36, v36, v62, v63
  v_max3_f32 v36, v36, v64, v65
  v_max3_f32 v36, v36, v66, v67
  v_max3_f32 v37, v37, v68, v69
  v_max3_f32 v37, v37, v70, v71
  v_max3_f32 v37, v37, v72, v73
  v_max3_f32 v37, v37, v74, v75
  v_max3_f32 v37, v37, v76, v77
  v_max3_f32 v37, v37, v78, v79
  v_max3_f32 v37, v37, v80, v81
  v_max3_f32 v37, v37, v82, v83
  ds_read_b128 v[22:25], v116 offset:14400
  ds_read_b64 v[26:27], v117 offset:14400
  s_waitcnt lgkmcnt(0)
  v_mfma_f32_32x32x16_bf16 v[52:67], v[22:25], v[10:13], 0
  v_mfma_f32_32x32x8_bf16 v[52:67], v[26:27], v[18:19], v[52:67]
  v_mfma_f32_32x32x16_bf16 v[68:83], v[22:25], v[14:17], 0
  v_mfma_f32_32x32x8_bf16 v[68:83], v[26:27], v[20:21], v[68:83]
  s_nop 15
  s_nop 7
  v_max3_f32 v36, v36, v52, v53
  v_max3_f32 v36, v36, v54, v55
  v_max3_f32 v36, v36, v56, v57
  v_max3_f32 v36, v36, v58, v59
  v_max3_f32 v36, v36, v60, v61
  v_max3_f32 v36, v36, v62, v63
  v_max3_f32 v36, v36, v64, v65
  v_max3_f32 v36, v36, v66, v67
  v_max3_f32 v37, v37, v68, v69
  v_max3_f32 v37, v37, v70, v71
  v_max3_f32 v37, v37, v72, v73
  v_max3_f32 v37, v37, v74, v75
  v_max3_f32 v37, v37, v76, v77
  v_max3_f32 v37, v37, v78, v79
  v_max3_f32 v37, v37, v80, v81
  v_max3_f32 v37, v37, v82, v83
  s_waitcnt vmcnt(0)
  s_barrier
  s_cmp_gt_u32 s48, 1
  s_cbranch_scc1 fk_ah4
  s_cmp_eq_u32 s48, 1
  s_cbranch_scc1 fk_ah14
  v_mov_b32 v0, 0
  global_load_dword v0, v0, s[56:57] sc0 sc1
  s_branch fk_ah4
fk_ah14:
  s_cmp_lg_u32 s60, 0
  s_cbranch_scc1 fk_ah4
  v_readfirstlane_b32 s60, v0
fk_ah4:
  s_add_u32 s50, s50, 23040
  s_cmp_ge_u32 s50, 69120
  s_cselect_b32 s50, 0, s50
  s_mov_b32 s49, 23040
  s_cmov_b32 s49, -46080
  v_add_u32 v116, s49, v116
  v_add_u32 v117, s49, v117
  s_cmp_ge_u32 s48, 6
  s_cbranch_scc1 fk_a_nodma1
  s_cmp_lg_u32 s43, 0
  s_cbranch_scc1 fk_a_nodma1
  s_add_u32 s45, s52, s47
  s_lshl_b32 s46, s53, 3
  s_add_u32 s46, s46, s18
  s_mul_i32 s46, s46, 123392
  s_mov_b32 m0, s45
  s_add_u32 s46, s46, 0
  buffer_load_dwordx4 v119, s[12:15], s46 offen lds
  buffer_load_dwordx4 v8, s[12:15], s46 offen offset:1024 lds
  s_mov_b32 exec_hi, 1048575
  buffer_load_dwordx4 v9, s[12:15], s46 offen offset:2048 lds
  s_mov_b32 exec_hi, -1
  s_add_u32 s46, s46, 493568
  s_add_u32 m0, s45, 11520
  s_nop 0
  buffer_load_dwordx4 v119, s[12:15], s46 offen lds
  buffer_load_dwordx4 v8, s[12:15], s46 offen offset:1024 lds
  s_mov_b32 exec_hi, 1048575
  buffer_load_dwordx4 v9, s[12:15], s46 offen offset:2048 lds
  s_mov_b32 exec_hi, -1
  s_add_u32 s53, s53, 1
  s_and_b32 s53, s53, 7
  s_add_u32 s52, s52, 23040
  s_cmp_ge_u32 s52, 69120
  s_cselect_b32 s52, 0, s52
fk_a_nodma1:
  v_add_u32 v118, s49, v118
  s_add_u32 s48, s48, 1
  s_cmp_lt_u32 s48, 8
  s_cbranch_scc1 fk_a_mxloopa
  s_branch fk_a_mxend
fk_a_mgrp1:
fk_a_mxloopb:
  ds_read_b128 v[22:25], v116 offset:0
  ds_read_b64 v[26:27], v117 offset:0
  s_waitcnt lgkmcnt(0)
  v_mfma_f32_32x32x16_bf16 v[52:67], v[22:25], v[10:13], 0
  v_mfma_f32_32x32x8_bf16 v[52:67], v[26:27], v[18:19], v[52:67]
  v_mfma_f32_32x32x16_bf16 v[68:83], v[22:25], v[14:17], 0
  v_mfma_f32_32x32x8_bf16 v[68:83], v[26:27], v[20:21], v[68:83]
  s_nop 15
  s_nop 7
  v_max3_f32 v36, v36, v52, v53
  v_max3_f32 v36, v36, v54, v55
  v_max3_f32 v36, v36, v56, v57
  v_max3_f32 v36, v36, v58, v59
  v_max3_f32 v36, v36, v60, v61
  v_max3_f32 v36, v36, v62, v63
  v_max3_f32 v36, v36, v64, v65
  v_max3_f32 v36, v36, v66, v67
  v_max3_f32 v37, v37, v68, v69
  v_max3_f32 v37, v37, v70, v71
  v_max3_f32 v37, v37, v72, v73
  v_max3_f32 v37, v37, v74, v75
  v_max3_f32 v37, v37, v76, v77
  v_max3_f32 v37, v37, v78, v79
  v_max3_f32 v37, v37, v80, v81
  v_max3_f32 v37, v37, v82, v83
  ds_read_b128 v[22:25], v116 offset:2880
  ds_read_b64 v[26:27], v117 offset:2880
  s_waitcnt lgkmcnt(0)
  v_mfma_f32_32x32x16_bf16 v[52:67], v[22:25], v[10:13], 0
  v_mfma_f32_32x32x8_bf16 v[52:67], v[26:27], v[18:19], v[52:67]
  v_mfma_f32_32x32x16_bf16 v[68:83], v[22:25], v[14:17], 0
  v_mfma_f32_32x32x8_bf16 v[68:83], v[26:27], v[20:21], v[68:83]
  s_nop 15
  s_nop 7
  v_max3_f32 v36, v36, v52, v53
  v_max3_f32 v36, v36, v54, v55
  v_max3_f32 v36, v36, v56, v57
  v_max3_f32 v36, v36, v58, v59
  v_max3_f32 v36, v36, v60, v61
  v_max3_f32 v36, v36, v62, v63
  v_max3_f32 v36, v36, v64, v65
  v_max3_f32 v36, v36, v66, v67
  v_max3_f32 v37, v37, v68, v69
  v_max3_f32 v37, v37, v70, v71
  v_max3_f32 v37, v37, v72, v73
  v_max3_f32 v37, v37, v74, v75
  v_max3_f32 v37, v37, v76, v77
  v_max3_f32 v37, v37, v78, v79
  v_max3_f32 v37, v37, v80, v81
  v_max3_f32 v37, v37, v82, v83
  s_waitcnt vmcnt(0)
  s_barrier
  s_cmp_gt_u32 s48, 1
  s_cbranch_scc1 fk_ah5
  s_cmp_eq_u32 s48, 1
  s_cbranch_scc1 fk_ah15
  v_mov_b32 v0, 0
  global_load_dword v0, v0, s[56:57] sc0 sc1
  s_branch fk_ah5
fk_ah15:
  s_cmp_lg_u32 s60, 0
  s_cbranch_scc1 fk_ah5
  v_readfirstlane_b32 s60, v0
fk_ah5:
  s_add_u32 s50, s50, 23040
  s_cmp_ge_u32 s50, 69120
  s_cselect_b32 s50, 0, s50
  s_mov_b32 s49, 23040
  s_cmov_b32 s49, -46080
  v_add_u32 v116, s49, v116
  v_add_u32 v117, s49, v117
  s_cmp_ge_u32 s48, 6
  s_cbranch_scc1 fk_a_nodma2
  s_cmp_lg_u32 s43, 0
  s_cbranch_scc1 fk_a_nodma2
  s_add_u32 s45, s52, s47
  s_lshl_b32 s46, s53, 3
  s_add_u32 s46, s46, s18
  s_mul_i32 s46, s46, 123392
  s_mov_b32 m0, s45
  s_add_u32 s46, s46, 0
  buffer_load_dwordx4 v119, s[12:15], s46 offen lds
  buffer_load_dwordx4 v8, s[12:15], s46 offen offset:1024 lds
  s_mov_b32 exec_hi, 1048575
  buffer_load_dwordx4 v9, s[12:15], s46 offen offset:2048 lds
  s_mov_b32 exec_hi, -1
  s_add_u32 s46, s46, 493568
  s_add_u32 m0, s45, 11520
  s_nop 0
  buffer_load_dwordx4 v119, s[12:15], s46 offen lds
  buffer_load_dwordx4 v8, s[12:15], s46 offen offset:1024 lds
  s_mov_b32 exec_hi, 1048575
  buffer_load_dwordx4 v9, s[12:15], s46 offen offset:2048 lds
  s_mov_b32 exec_hi, -1
  s_add_u32 s53, s53, 1
  s_and_b32 s53, s53, 7
  s_add_u32 s52, s52, 23040
  s_cmp_ge_u32 s52, 69120
  s_cselect_b32 s52, 0, s52
fk_a_nodma2:
  v_add_u32 v118, s49, v118
  s_add_u32 s48, s48, 1
  s_cmp_lt_u32 s48, 8
  s_cbranch_scc1 fk_a_mxloopb
fk_a_mxend:
  v_subrev_u32 v116, 46080, v116
  v_subrev_u32 v117, 46080, v117
  v_subrev_u32 v118, 46080, v118
  v_mov_b32 v68, v36
  v_mov_b32 v69, v36
  s_nop 1
  v_permlane32_swap_b32 v68, v69
  s_nop 1
  v_max_f32 v36, v68, v69
  v_mov_b32 v68, v37
  v_mov_b32 v69, v37
  s_nop 1
  v_permlane32_swap_b32 v68, v69
  s_nop 1
  v_max_f32 v37, v68, v69
  s_lshl_b32 s44, s18, 9
  v_lshlrev_b32 v68, 3, v1
  v_add_u32 v69, s44, v68
  s_xor_b32 s45, s18, 4
  s_lshl_b32 s45, s45, 9
  v_add_u32 v70, s45, v68
  s_waitcnt vmcnt(0)
  s_barrier
  ds_write_b64 v69, v[36:37]
  s_waitcnt lgkmcnt(0)
  s_barrier
  ds_read_b64 v[72:73], v70
  s_waitcnt lgkmcnt(0)
  v_max_f32 v36, v36, v72
  v_max_f32 v37, v37, v73
  s_barrier
  s_mov_b32 exec_lo, 0
  v_xor_b32 v68, 0x80000000, v36
  v_and_b32 v69, 0xffff0000, v68
  v_sub_f32 v68, v68, v69
  v_and_b32 v70, 0xffff0000, v68
  v_sub_f32 v68, v68, v70
  v_lshrrev_b32 v69, 16, v69
  v_or_b32 v18, v69, v70
  v_lshrrev_b32 v19, 16, v68
  v_xor_b32 v68, 0x80000000, v37
  v_and_b32 v69, 0xffff0000, v68
  v_sub_f32 v68, v68, v69
  v_and_b32 v70, 0xffff0000, v68
  v_sub_f32 v68, v68, v70
  v_lshrrev_b32 v69, 16, v69
  v_or_b32 v20, v69, v70
  v_lshrrev_b32 v21, 16, v68
  s_mov_b32 exec_lo, -1
  s_mov_b32 s53, 0
  s_mov_b32 s45, s47
  s_lshl_b32 s46, s53, 3
  s_add_u32 s46, s46, s18
  s_mul_i32 s46, s46, 123392
  s_mov_b32 m0, s45
  s_add_u32 s46, s46, 0
  buffer_load_dwordx4 v119, s[12:15], s46 offen lds
  buffer_load_dwordx4 v8, s[12:15], s46 offen offset:1024 lds
  s_mov_b32 exec_hi, 1048575
  buffer_load_dwordx4 v9, s[12:15], s46 offen offset:2048 lds
  s_mov_b32 exec_hi, -1
  s_add_u32 s53, s53, 1
  s_and_b32 s53, s53, 7
  s_add_u32 s45, s45, 23040
  s_lshl_b32 s46, s53, 3
  s_add_u32 s46, s46, s18
  s_mul_i32 s46, s46, 123392
  s_mov_b32 m0, s45
  s_add_u32 s46, s46, 0
  buffer_load_dwordx4 v119, s[12:15], s46 offen lds
  buffer_load_dwordx4 v8, s[12:15], s46 offen offset:1024 lds
  s_mov_b32 exec_hi, 1048575
  buffer_load_dwordx4 v9, s[12:15], s46 offen offset:2048 lds
  s_mov_b32 exec_hi, -1
  s_add_u32 s53, s53, 1
  s_and_b32 s53, s53, 7
  s_branch fk_a_restart
fk_a_att_done:
  s_branch fk_end
fk_frole:
  s_load_dwordx2 s[8:9], s[0:1], 32
  s_load_dwordx2 s[20:21], s[0:1], 40
  s_load_dwordx2 s[24:25], s[0:1], 48
  s_load_dwordx2 s[28:29], s[0:1], 16
  s_load_dwordx2 s[32:33], s[0:1], 56
  s_load_dwordx2 s[36:37], s[0:1], 72
  s_load_dwordx2 s[84:85], s[0:1], 64
  s_sub_u32 s19, s2, 256
  s_waitcnt lgkmcnt(0)
  s_mov_b32 s12, s58
  s_mov_b32 s13, s59
  s_mov_b32 s6, 2621440
  s_mov_b32 s7, 0x20000
  s_mov_b32 s14, 268435456
  s_mov_b32 s15, 0x20000
  s_mov_b32 s10, 1966080
  s_mov_b32 s11, 0x20000
  s_mov_b32 s22, 3072
  s_mov_b32 s23, 0x20000
  s_mov_b32 s26, 1966080
  s_mov_b32 s27, 0x20000
  s_mov_b32 s30, 819200
  s_mov_b32 s31, 0x20000
  s_mov_b32 s34, 1280
  s_mov_b32 s35, 0x20000
  s_mov_b32 s38, 2621440
  s_mov_b32 s39, 0x20000
  s_mov_b32 s86, 1280
  s_mov_b32 s87, 0x20000
  s_setprio 3
  s_and_b32 s42, s19, 7
  s_lshr_b32 s43, s19, 3
  s_lshr_b32 s40, s42, 1
  s_lshl_b32 s40, s40, 2
  s_and_b32 s41, s43, 3
  s_add_u32 s40, s40, s41
  s_and_b32 s41, s42, 1
  s_lshl_b32 s41, s41, 3
  s_lshr_b32 s43, s43, 2
  s_add_u32 s41, s41, s43
  s_cmp_lt_u32 s18, 4
  s_cbranch_scc1 fk_1_f1c
  s_sub_u32 s49, s18, 4
  v_lshrrev_b32 v2, 2, v1
  v_lshrrev_b32 v3, 4, v1
  v_sub_u32 v3, 0, v3
  v_and_b32 v3, 3, v3
  v_and_b32 v4, 3, v1
  v_xor_b32 v4, v4, v3
  s_lshl_b32 s42, s40, 7
  s_lshl_b32 s43, s49, 5
  s_add_u32 s42, s42, s43
  v_add_u32 v2, s42, v2
  v_mul_u32_u24 v2, 1280, v2
  v_lshl_add_u32 v6, v4, 4, v2
  v_add_u32 v7, 19456, v6
  s_mul_i32 s42, s49, 96
  v_add_u32 v2, s42, v1
  v_add_u32 v2, 0, v2
  v_mul_u32_u24 v3, 5462, v2
  v_lshrrev_b32 v3, 16, v3
  v_mul_u32_u24 v4, 12, v3
  v_sub_u32 v4, v2, v4
  v_mul_u32_u24 v3, 3072, v3
  v_lshl_add_u32 v8, v4, 4, v3
  s_mul_i32 s43, s41, 192
  s_sub_u32 s43, s43, 0
  v_add_u32 v8, s43, v8
  v_add_u32 v2, s42, v1
  v_add_u32 v2, 64, v2
  v_mul_u32_u24 v3, 5462, v2
  v_lshrrev_b32 v3, 16, v3
  v_mul_u32_u24 v4, 12, v3
  v_sub_u32 v4, v2, v4
  v_mul_u32_u24 v3, 3072, v3
  v_lshl_add_u32 v9, v4, 4, v3
  s_mul_i32 s43, s41, 192
  s_sub_u32 s43, s43, 1024
  v_add_u32 v9, s43, v9
  s_lshl_b32 s44, s49, 11
  s_mul_i32 s45, s49, 1536
  s_add_u32 s45, s45, 8192
  s_add_u32 s48, s40, s41
  s_mul_i32 s42, s48, 16384
  s_lshr_b32 s42, s42, 16
  s_mul_i32 s42, s42, 4
  s_sub_u32 s48, s48, s42
  s_mul_i32 s48, s48, 5
  s_and_b32 s90, s19, 7
  s_lshr_b32 s91, s19, 3
  s_lshr_b32 s88, s90, 1
  s_lshl_b32 s88, s88, 3
  s_and_b32 s89, s91, 7
  s_add_u32 s88, s88, s89
  s_and_b32 s89, s90, 1
  s_lshl_b32 s89, s89, 2
  s_lshr_b32 s91, s91, 3
  s_add_u32 s89, s89, s91
  s_sub_u32 s92, s18, 4
  v_lshrrev_b32 v2, 2, v1
  v_lshrrev_b32 v3, 4, v1
  v_sub_u32 v3, 0, v3
  v_and_b32 v3, 3, v3
  v_and_b32 v4, 3, v1
  v_xor_b32 v4, v4, v3
  s_lshl_b32 s90, s88, 6
  s_and_b32 s91, s92, 1
  s_lshl_b32 s91, s91, 5
  s_add_u32 s90, s90, s91
  v_add_u32 v2, s90, v2
  v_lshlrev_b32 v2, 6, v2
  v_lshl_add_u32 v40, v4, 4, v2
  s_lshr_b32 s90, s92, 1
  s_lshl_b32 s90, s90, 17
  v_add_u32 v40, s90, v40
  s_mul_i32 s90, s92, 160
  v_add_u32 v2, s90, v1
  v_add_u32 v2, 0, v2
  v_mul_u32_u24 v3, 6554, v2
  v_lshrrev_b32 v3, 16, v3
  v_mul_u32_u24 v4, 10, v3
  v_sub_u32 v4, v2, v4
  v_and_b32 v2, 0x33, v3
  v_and_b32 v5, 4, v3
  v_lshl_or_b32 v2, v5, 1, v2
  v_and_b32 v5, 8, v3
  v_lshrrev_b32 v5, 1, v5
  v_or_b32 v2, v2, v5
  v_mul_u32_u24 v3, 1280, v2
  v_lshl_add_u32 v41, v4, 4, v3
  s_mul_i32 s91, s89, 160
  s_sub_u32 s91, s91, 0
  v_add_u32 v41, s91, v41
  v_add_u32 v2, s90, v1
  v_add_u32 v2, 64, v2
  v_mul_u32_u24 v3, 6554, v2
  v_lshrrev_b32 v3, 16, v3
  v_mul_u32_u24 v4, 10, v3
  v_sub_u32 v4, v2, v4
  v_and_b32 v2, 0x33, v3
  v_and_b32 v5, 4, v3
  v_lshl_or_b32 v2, v5, 1, v2
  v_and_b32 v5, 8, v3
  v_lshrrev_b32 v5, 1, v5
  v_or_b32 v2, v2, v5
  v_mul_u32_u24 v3, 1280, v2
  v_lshl_add_u32 v42, v4, 4, v3
  s_mul_i32 s91, s89, 160
  s_sub_u32 s91, s91, 1024
  v_add_u32 v42, s91, v42
  v_add_u32 v2, s90, v1
  v_add_u32 v2, 128, v2
  v_mul_u32_u24 v3, 6554, v2
  v_lshrrev_b32 v3, 16, v3
  v_mul_u32_u24 v4, 10, v3
  v_sub_u32 v4, v2, v4
  v_and_b32 v2, 0x33, v3
  v_and_b32 v5, 4, v3
  v_lshl_or_b32 v2, v5, 1, v2
  v_and_b32 v5, 8, v3
  v_lshrrev_b32 v5, 1, v5
  v_or_b32 v2, v2, v5
  v_mul_u32_u24 v3, 1280, v2
  v_lshl_add_u32 v43, v4, 4, v3
  s_mul_i32 s91, s89, 160
  s_sub_u32 s91, s91, 2048
  v_add_u32 v43, s91, v43
  s_mul_i32 s90, s92, 200
  v_add_u32 v2, s90, v1
  v_add_u32 v2, 0, v2
  v_mul_u32_u24 v3, 6554, v2
  v_lshrrev_b32 v3, 16, v3
  v_mul_u32_u24 v4, 10, v3
  v_sub_u32 v4, v2, v4
  v_bfe_u32 v2, v3, 4, 1
  v_bfe_u32 v5, v3, 2, 1
  v_lshl_add_u32 v2, v2, 1, v5
  v_mul_u32_u24 v2, 20, v2
  v_bfe_u32 v5, v3, 3, 1
  v_lshl_add_u32 v2, v5, 2, v2
  v_and_b32 v5, 3, v3
  v_add_u32 v2, v2, v5
  v_bfe_u32 v5, v3, 5, 1
  v_lshl_add_u32 v2, v5, 3, v2
  v_bfe_u32 v5, v3, 2, 2
  v_mul_u32_u24 v5, 20, v5
  v_and_b32 v44, 3, v3
  v_add_u32 v5, v5, v44
  v_add_u32 v5, 16, v5
  v_cmp_le_u32 vcc, 64, v3
  s_nop 1
  v_cndmask_b32 v2, v2, v5, vcc
  v_mul_u32_u24 v3, 1280, v2
  v_lshl_add_u32 v44, v4, 4, v3
  s_mul_i32 s91, s89, 160
  s_sub_u32 s91, s91, 0
  v_add_u32 v44, s91, v44
  v_add_u32 v2, s90, v1
  v_add_u32 v2, 64, v2
  v_mul_u32_u24 v3, 6554, v2
  v_lshrrev_b32 v3, 16, v3
  v_mul_u32_u24 v4, 10, v3
  v_sub_u32 v4, v2, v4
  v_bfe_u32 v2, v3, 4, 1
  v_bfe_u32 v5, v3, 2, 1
  v_lshl_add_u32 v2, v2, 1, v5
  v_mul_u32_u24 v2, 20, v2
  v_bfe_u32 v5, v3, 3, 1
  v_lshl_add_u32 v2, v5, 2, v2
  v_and_b32 v5, 3, v3
  v_add_u32 v2, v2, v5
  v_bfe_u32 v5, v3, 5, 1
  v_lshl_add_u32 v2, v5, 3, v2
  v_bfe_u32 v5, v3, 2, 2
  v_mul_u32_u24 v5, 20, v5
  v_and_b32 v45, 3, v3
  v_add_u32 v5, v5, v45
  v_add_u32 v5, 16, v5
  v_cmp_le_u32 vcc, 64, v3
  s_nop 1
  v_cndmask_b32 v2, v2, v5, vcc
  v_mul_u32_u24 v3, 1280, v2
  v_lshl_add_u32 v45, v4, 4, v3
  s_mul_i32 s91, s89, 160
  s_sub_u32 s91, s91, 1024
  v_add_u32 v45, s91, v45
  v_add_u32 v2, s90, v1
  v_add_u32 v2, 128, v2
  v_mul_u32_u24 v3, 6554, v2
  v_lshrrev_b32 v3, 16, v3
  v_mul_u32_u24 v4, 10, v3
  v_sub_u32 v4, v2, v4
  v_bfe_u32 v2, v3, 4, 1
  v_bfe_u32 v5, v3, 2, 1
  v_lshl_add_u32 v2, v2, 1, v5
  v_mul_u32_u24 v2, 20, v2
  v_bfe_u32 v5, v3, 3, 1
  v_lshl_add_u32 v2, v5, 2, v2
  v_and_b32 v5, 3, v3
  v_add_u32 v2, v2, v5
  v_bfe_u32 v5, v3, 5, 1
  v_lshl_add_u32 v2, v5, 3, v2
  v_bfe_u32 v5, v3, 2, 2
  v_mul_u32_u24 v5, 20, v5
  v_and_b32 v46, 3, v3
  v_add_u32 v5, v5, v46
  v_add_u32 v5, 16, v5
  v_cmp_le_u32 vcc, 64, v3
  s_nop 1
  v_cndmask_b32 v2, v2, v5, vcc
  v_mul_u32_u24 v3, 1280, v2
  v_lshl_add_u32 v46, v4, 4, v3
  s_mul_i32 s91, s89, 160
  s_sub_u32 s91, s91, 2048
  v_add_u32 v46, s91, v46
  v_add_u32 v2, s90, v1
  v_add_u32 v2, 192, v2
  v_mul_u32_u24 v3, 6554, v2
  v_lshrrev_b32 v3, 16, v3
  v_mul_u32_u24 v4, 10, v3
  v_sub_u32 v4, v2, v4
  v_bfe_u32 v2, v3, 4, 1
  v_bfe_u32 v5, v3, 2, 1
  v_lshl_add_u32 v2, v2, 1, v5
  v_mul_u32_u24 v2, 20, v2
  v_bfe_u32 v5, v3, 3, 1
  v_lshl_add_u32 v2, v5, 2, v2
  v_and_b32 v5, 3, v3
  v_add_u32 v2, v2, v5
  v_bfe_u32 v5, v3, 5, 1
  v_lshl_add_u32 v2, v5, 3, v2
  v_bfe_u32 v5, v3, 2, 2
  v_mul_u32_u24 v5, 20, v5
  v_and_b32 v47, 3, v3
  v_add_u32 v5, v5, v47
  v_add_u32 v5, 16, v5
  v_cmp_le_u32 vcc, 64, v3
  s_nop 1
  v_cndmask_b32 v2, v2, v5, vcc
  v_mul_u32_u24 v3, 1280, v2
  v_lshl_add_u32 v47, v4, 4, v3
  s_mul_i32 s91, s89, 160
  s_sub_u32 s91, s91, 3072
  v_add_u32 v47, s91, v47
  v_lshlrev_b32 v48, 4, v1
  s_add_u32 m0, s44, 0
  s_lshl_b32 s46, s48, 6
  s_mul_i32 s47, s48, 98304
  buffer_load_dwordx4 v6, s[4:7], s46 offen lds
  buffer_load_dwordx4 v7, s[4:7], s46 offen offset:1024 lds
  s_add_u32 m0, s45, 0
  s_add_u32 s48, s48, 1
  buffer_load_dwordx4 v8, s[8:11], s47 offen lds
  s_mov_b32 exec_hi, 0
  buffer_load_dwordx4 v9, s[8:11], s47 offen offset:1024 lds
  s_mov_b32 exec_hi, -1
  s_cmp_eq_u32 s48, 20
  s_cselect_b32 s48, 0, s48
  s_add_u32 m0, s44, 14336
  s_lshl_b32 s46, s48, 6
  s_mul_i32 s47, s48, 98304
  buffer_load_dwordx4 v6, s[4:7], s46 offen lds
  buffer_load_dwordx4 v7, s[4:7], s46 offen offset:1024 lds
  s_add_u32 m0, s45, 14336
  s_add_u32 s48, s48, 1
  buffer_load_dwordx4 v8, s[8:11], s47 offen lds
  s_mov_b32 exec_hi, 0
  buffer_load_dwordx4 v9, s[8:11], s47 offen offset:1024 lds
  s_mov_b32 exec_hi, -1
  s_cmp_eq_u32 s48, 20
  s_cselect_b32 s48, 0, s48
  s_setprio 1
  s_waitcnt vmcnt(4)
  s_barrier
  s_add_u32 m0, s44, 28672
  s_lshl_b32 s46, s48, 6
  s_mul_i32 s47, s48, 98304
  buffer_load_dwordx4 v6, s[4:7], s46 offen lds
  buffer_load_dwordx4 v7, s[4:7], s46 offen offset:1024 lds
  s_add_u32 m0, s45, 28672
  s_add_u32 s48, s48, 1
  buffer_load_dwordx4 v8, s[8:11], s47 offen lds
  s_mov_b32 exec_hi, 0
  buffer_load_dwordx4 v9, s[8:11], s47 offen offset:1024 lds
  s_mov_b32 exec_hi, -1
  s_cmp_eq_u32 s48, 20
  s_cselect_b32 s48, 0, s48
  s_add_u32 m0, s44, 43008
  s_lshl_b32 s46, s48, 6
  s_mul_i32 s47, s48, 98304
  buffer_load_dwordx4 v6, s[4:7], s46 offen lds
  buffer_load_dwordx4 v7, s[4:7], s46 offen offset:1024 lds
  s_add_u32 m0, s45, 43008
  s_add_u32 s48, s48, 1
  buffer_load_dwordx4 v8, s[8:11], s47 offen lds
  s_mov_b32 exec_hi, 0
  buffer_load_dwordx4 v9, s[8:11], s47 offen offset:1024 lds
  s_mov_b32 exec_hi, -1
  s_cmp_eq_u32 s48, 20
  s_cselect_b32 s48, 0, s48
  s_mov_b32 s52, 3
fk_1_f1ll:
  s_waitcnt vmcnt(8)
  s_barrier
  s_add_u32 m0, s44, 57344
  s_lshl_b32 s46, s48, 6
  s_mul_i32 s47, s48, 98304
  buffer_load_dwordx4 v6, s[4:7], s46 offen lds
  buffer_load_dwordx4 v7, s[4:7], s46 offen offset:1024 lds
  s_add_u32 m0, s45, 57344
  s_add_u32 s48, s48, 1
  buffer_load_dwordx4 v8, s[8:11], s47 offen lds
  s_mov_b32 exec_hi, 0
  buffer_load_dwordx4 v9, s[8:11], s47 offen offset:1024 lds
  s_mov_b32 exec_hi, -1
  s_cmp_eq_u32 s48, 20
  s_cselect_b32 s48, 0, s48
  s_waitcnt vmcnt(8)
  s_barrier
  s_add_u32 m0, s44, 0
  s_lshl_b32 s46, s48, 6
  s_mul_i32 s47, s48, 98304
  buffer_load_dwordx4 v6, s[4:7], s46 offen lds
  buffer_load_dwordx4 v7, s[4:7], s46 offen offset:1024 lds
  s_add_u32 m0, s45, 0
  s_add_u32 s48, s48, 1
  buffer_load_dwordx4 v8, s[8:11], s47 offen lds
  s_mov_b32 exec_hi, 0
  buffer_load_dwordx4 v9, s[8:11], s47 offen offset:1024 lds
  s_mov_b32 exec_hi, -1
  s_cmp_eq_u32 s48, 20
  s_cselect_b32 s48, 0, s48
  s_waitcnt vmcnt(8)
  s_barrier
  s_add_u32 m0, s44, 14336
  s_lshl_b32 s46, s48, 6
  s_mul_i32 s47, s48, 98304
  buffer_load_dwordx4 v6, s[4:7], s46 offen lds
  buffer_load_dwordx4 v7, s[4:7], s46 offen offset:1024 lds
  s_add_u32 m0, s45, 14336
  s_add_u32 s48, s48, 1
  buffer_load_dwordx4 v8, s[8:11], s47 offen lds
  s_mov_b32 exec_hi, 0
  buffer_load_dwordx4 v9, s[8:11], s47 offen offset:1024 lds
  s_mov_b32 exec_hi, -1
  s_cmp_eq_u32 s48, 20
  s_cselect_b32 s48, 0, s48
  s_waitcnt vmcnt(8)
  s_barrier
  s_add_u32 m0, s44, 28672
  s_lshl_b32 s46, s48, 6
  s_mul_i32 s47, s48, 98304
  buffer_load_dwordx4 v6, s[4:7], s46 offen lds
  buffer_load_dwordx4 v7, s[4:7], s46 offen offset:1024 lds
  s_add_u32 m0, s45, 28672
  s_add_u32 s48, s48, 1
  buffer_load_dwordx4 v8, s[8:11], s47 offen lds
  s_mov_b32 exec_hi, 0
  buffer_load_dwordx4 v9, s[8:11], s47 offen offset:1024 lds
  s_mov_b32 exec_hi, -1
  s_cmp_eq_u32 s48, 20
  s_cselect_b32 s48, 0, s48
  s_waitcnt vmcnt(8)
  s_barrier
  s_add_u32 m0, s44, 43008
  s_lshl_b32 s46, s48, 6
  s_mul_i32 s47, s48, 98304
  buffer_load_dwordx4 v6, s[4:7], s46 offen lds
  buffer_load_dwordx4 v7, s[4:7], s46 offen offset:1024 lds
  s_add_u32 m0, s45, 43008
  s_add_u32 s48, s48, 1
  buffer_load_dwordx4 v8, s[8:11], s47 offen lds
  s_mov_b32 exec_hi, 0
  buffer_load_dwordx4 v9, s[8:11], s47 offen offset:1024 lds
  s_mov_b32 exec_hi, -1
  s_cmp_eq_u32 s48, 20
  s_cselect_b32 s48, 0, s48
  s_sub_u32 s52, s52, 1
  s_cmp_lg_u32 s52, 0
  s_cbranch_scc1 fk_1_f1ll
  s_waitcnt vmcnt(8)
  s_barrier
  s_add_u32 m0, s44, 57344
  s_lshl_b32 s46, s48, 6
  s_mul_i32 s47, s48, 98304
  buffer_load_dwordx4 v6, s[4:7], s46 offen lds
  buffer_load_dwordx4 v7, s[4:7], s46 offen offset:1024 lds
  s_add_u32 m0, s45, 57344
  s_add_u32 s48, s48, 1
  buffer_load_dwordx4 v8, s[8:11], s47 offen lds
  s_mov_b32 exec_hi, 0
  buffer_load_dwordx4 v9, s[8:11], s47 offen offset:1024 lds
  s_mov_b32 exec_hi, -1
  s_cmp_eq_u32 s48, 20
  s_cselect_b32 s48, 0, s48
  s_waitcnt vmcnt(8)
  s_barrier
  s_waitcnt vmcnt(4)
  s_barrier
  s_waitcnt vmcnt(0)
  s_barrier
  s_barrier
  s_setprio 3
  s_branch fk_1_f1done
fk_1_f1c:
  s_mul_i32 s42, s41, 192
  v_lshrrev_b32 v3, 5, v1
  v_lshlrev_b32 v2, 4, v3
  buffer_load_dwordx4 v[32:35], v2, s[20:23], s42 offen offset:0
  buffer_load_dwordx4 v[36:39], v2, s[20:23], s42 offen offset:32
  buffer_load_dwordx4 v[40:43], v2, s[20:23], s42 offen offset:64
  buffer_load_dwordx4 v[44:47], v2, s[20:23], s42 offen offset:96
  buffer_load_dwordx4 v[48:51], v2, s[20:23], s42 offen offset:128
  buffer_load_dwordx4 v[52:55], v2, s[20:23], s42 offen offset:160
  v_and_b32 v2, 31, v1
  v_lshrrev_b32 v4, 2, v2
  v_sub_u32 v4, 0, v4
  v_and_b32 v4, 3, v4
  v_xor_b32 v4, v4, v3
  v_lshlrev_b32 v4, 4, v4
  v_lshl_add_u32 v2, v2, 6, v4
  s_lshl_b32 s42, s18, 11
  v_add_u32 v6, s42, v2
  v_xor_b32 v7, 32, v6
  v_add_u32 v8, 43008, v6
  v_add_u32 v9, 43008, v7
  v_lshrrev_b32 v2, 5, v1
  v_bfe_u32 v4, v1, 2, 2
  v_lshl_add_u32 v2, v2, 3, v4
  v_mul_u32_u24 v2, 192, v2
  v_add_u32 v2, 8192, v2
  v_bfe_u32 v3, v1, 4, 1
  v_lshlrev_b32 v10, 5, v3
  v_and_b32 v4, 1, v1
  v_lshl_add_u32 v10, v4, 4, v10
  v_bfe_u32 v4, v1, 1, 1
  v_lshl_add_u32 v10, v4, 3, v10
  v_add_u32 v10, v10, v2
  v_add_u32 v11, 43008, v10
  s_lshl_b32 s53, s40, 7
  s_lshl_b32 s54, s41, 3
  s_add_u32 s53, s53, s54
  s_lshl_b32 s54, s18, 1
  s_add_u32 s53, s53, s54
  s_mul_i32 s54, s53, 1280
  s_lshl_b32 s55, s53, 2
  s_add_u32 s55, s55, 18874368
  v_lshlrev_b32 v3, 5, v1
  v_mov_b32 v56, 0
  v_mov_b32 v57, 0
  v_mov_b32 v58, 0
  v_mov_b32 v59, 0
  v_mov_b32 v60, 0
  v_mov_b32 v61, 0
  v_mov_b32 v62, 0
  v_mov_b32 v63, 0
  v_mov_b32 v64, 0
  v_mov_b32 v65, 0
  v_mov_b32 v66, 0
  v_mov_b32 v67, 0
  v_mov_b32 v68, 0
  v_mov_b32 v69, 0
  v_mov_b32 v70, 0
  v_mov_b32 v71, 0
  v_mov_b32 v72, 0
  v_mov_b32 v73, 0
  v_mov_b32 v74, 0
  v_mov_b32 v75, 0
  v_mov_b32 v76, 0
  v_mov_b32 v77, 0
  v_mov_b32 v78, 0
  v_mov_b32 v79, 0
  s_mov_b32 exec_hi, 0xff
  buffer_load_dwordx4 v[56:59], v3, s[4:7], s54 offen
  buffer_load_dwordx4 v[60:63], v3, s[4:7], s54 offen offset:16
  buffer_load_dwordx4 v[64:67], v3, s[4:7], s54 offen offset:1280
  buffer_load_dwordx4 v[68:71], v3, s[4:7], s54 offen offset:1296
  buffer_load_dwordx4 v[72:75], v3, s[84:87], 0 offen
  buffer_load_dwordx4 v[76:79], v3, s[84:87], 0 offen offset:16
  s_mov_b32 exec_hi, -1
  s_waitcnt vmcnt(0)
  v_mov_b32 v80, 0
  v_mov_b32 v81, 0
  v_dot2_f32_bf16 v80, v56, v72, v80
  v_dot2_f32_bf16 v81, v64, v72, v81
  v_dot2_f32_bf16 v80, v57, v73, v80
  v_dot2_f32_bf16 v81, v65, v73, v81
  v_dot2_f32_bf16 v80, v58, v74, v80
  v_dot2_f32_bf16 v81, v66, v74, v81
  v_dot2_f32_bf16 v80, v59, v75, v80
  v_dot2_f32_bf16 v81, v67, v75, v81
  v_dot2_f32_bf16 v80, v60, v76, v80
  v_dot2_f32_bf16 v81, v68, v76, v81
  v_dot2_f32_bf16 v80, v61, v77, v80
  v_dot2_f32_bf16 v81, v69, v77, v81
  v_dot2_f32_bf16 v80, v62, v78, v80
  v_dot2_f32_bf16 v81, v70, v78, v81
  v_dot2_f32_bf16 v80, v63, v79, v80
  v_dot2_f32_bf16 v81, v71, v79, v81
  s_nop 3
  v_add_f32_dpp v80, v80, v80 row_shr:1 row_mask:0xf bank_mask:0xf bound_ctrl:0
  v_add_f32_dpp v81, v81, v81 row_shr:1 row_mask:0xf bank_mask:0xf bound_ctrl:0
  s_nop 1
  v_add_f32_dpp v80, v80, v80 row_shr:2 row_mask:0xf bank_mask:0xf bound_ctrl:0
  v_add_f32_dpp v81, v81, v81 row_shr:2 row_mask:0xf bank_mask:0xf bound_ctrl:0
  s_nop 1
  v_add_f32_dpp v80, v80, v80 row_shr:4 row_mask:0xf bank_mask:0xf bound_ctrl:0
  v_add_f32_dpp v81, v81, v81 row_shr:4 row_mask:0xf bank_mask:0xf bound_ctrl:0
  s_nop 1
  v_add_f32_dpp v80, v80, v80 row_shr:8 row_mask:0xf bank_mask:0xf bound_ctrl:0
  v_add_f32_dpp v81, v81, v81 row_shr:8 row_mask:0xf bank_mask:0xf bound_ctrl:0
  s_nop 1
  v_add_f32_dpp v80, v80, v80 row_bcast:15 row_mask:0xa bank_mask:0xf
  v_add_f32_dpp v81, v81, v81 row_bcast:15 row_mask:0xa bank_mask:0xf
  s_nop 1
  v_add_f32_dpp v80, v80, v80 row_bcast:31 row_mask:0xc bank_mask:0xf
  v_add_f32_dpp v81, v81, v81 row_bcast:31 row_mask:0xc bank_mask:0xf
  s_nop 1
  v_mul_f32 v80, 0xbfb8aa3b, v80
  v_mul_f32 v81, 0xbfb8aa3b, v81
  v_exp_f32 v80, v80
  v_exp_f32 v81, v81
  s_nop 0
  v_add_f32 v80, 1.0, v80
  v_add_f32 v81, 1.0, v81
  v_rcp_f32 v80, v80
  v_rcp_f32 v81, v81
  v_mov_b32 v4, 0
  s_mov_b32 exec_lo, 0
  s_mov_b32 exec_hi, 0x80000000
  buffer_store_dwordx2 v[80:81], v4, s[12:15], s55 offen sc1
  s_mov_b64 exec, -1
  s_waitcnt vmcnt(0)
  v_lshlrev_b32 v56, 16, v32
  v_and_b32 v57, 0xffff0000, v32
  v_lshlrev_b32 v58, 16, v33
  v_and_b32 v59, 0xffff0000, v33
  v_lshlrev_b32 v60, 16, v34
  v_and_b32 v61, 0xffff0000, v34
  v_lshlrev_b32 v62, 16, v35
  v_and_b32 v63, 0xffff0000, v35
  v_lshlrev_b32 v64, 16, v36
  v_and_b32 v65, 0xffff0000, v36
  v_lshlrev_b32 v66, 16, v37
  v_and_b32 v67, 0xffff0000, v37
  v_lshlrev_b32 v68, 16, v38
  v_and_b32 v69, 0xffff0000, v38
  v_lshlrev_b32 v70, 16, v39
  v_and_b32 v71, 0xffff0000, v39
  v_lshlrev_b32 v72, 16, v40
  v_and_b32 v73, 0xffff0000, v40
  v_lshlrev_b32 v74, 16, v41
  v_and_b32 v75, 0xffff0000, v41
  v_lshlrev_b32 v76, 16, v42
  v_and_b32 v77, 0xffff0000, v42
  v_lshlrev_b32 v78, 16, v43
  v_and_b32 v79, 0xffff0000, v43
  v_lshlrev_b32 v80, 16, v44
  v_and_b32 v81, 0xffff0000, v44
  v_lshlrev_b32 v82, 16, v45
  v_and_b32 v83, 0xffff0000, v45
  v_lshlrev_b32 v84, 16, v46
  v_and_b32 v85, 0xffff0000, v46
  v_lshlrev_b32 v86, 16, v47
  v_and_b32 v87, 0xffff0000, v47
  v_lshlrev_b32 v88, 16, v48
  v_and_b32 v89, 0xffff0000, v48
  v_lshlrev_b32 v90, 16, v49
  v_and_b32 v91, 0xffff0000, v49
  v_lshlrev_b32 v92, 16, v50
  v_and_b32 v93, 0xffff0000, v50
  v_lshlrev_b32 v94, 16, v51
  v_and_b32 v95, 0xffff0000, v51
  v_lshlrev_b32 v96, 16, v52
  v_and_b32 v97, 0xffff0000, v52
  v_lshlrev_b32 v98, 16, v53
  v_and_b32 v99, 0xffff0000, v53
  v_lshlrev_b32 v100, 16, v54
  v_and_b32 v101, 0xffff0000, v54
  v_lshlrev_b32 v102, 16, v55
  v_and_b32 v103, 0xffff0000, v55
  s_mov_b32 s52, 4
  s_barrier
  s_setprio 0
  ds_read_b128 v[12:15], v6 offset:0
  ds_read_b64_tr_b16 v[20:21], v10 offset:0
  ds_read_b64_tr_b16 v[22:23], v10 offset:768
  ds_read_b64_tr_b16 v[24:25], v10 offset:64
  ds_read_b64_tr_b16 v[26:27], v10 offset:832
  ds_read_b64_tr_b16 v[28:29], v10 offset:128
  ds_read_b64_tr_b16 v[30:31], v10 offset:896
.p2align 6
fk_1_f1cl:
  ds_read_b128 v[16:19], v7 offset:0
  s_waitcnt lgkmcnt(5)
  v_mfma_f32_32x32x16_bf16 v[56:71], v[20:23], v[12:15], v[56:71]
  ds_read_b64_tr_b16 v[20:21], v10 offset:3072
  ds_read_b64_tr_b16 v[22:23], v10 offset:3840
  s_waitcnt lgkmcnt(5)
  v_mfma_f32_32x32x16_bf16 v[72:87], v[24:27], v[12:15], v[72:87]
  ds_read_b64_tr_b16 v[24:25], v10 offset:3136
  ds_read_b64_tr_b16 v[26:27], v10 offset:3904
  s_waitcnt lgkmcnt(5)
  v_mfma_f32_32x32x16_bf16 v[88:103], v[28:31], v[12:15], v[88:103]
  ds_read_b64_tr_b16 v[28:29], v10 offset:3200
  ds_read_b64_tr_b16 v[30:31], v10 offset:3968
  s_barrier
  ds_read_b128 v[12:15], v6 offset:14336
  s_waitcnt lgkmcnt(5)
  v_mfma_f32_32x32x16_bf16 v[56:71], v[20:23], v[16:19], v[56:71]
  ds_read_b64_tr_b16 v[20:21], v10 offset:14336
  ds_read_b64_tr_b16 v[22:23], v10 offset:15104
  s_waitcnt lgkmcnt(5)
  v_mfma_f32_32x32x16_bf16 v[72:87], v[24:27], v[16:19], v[72:87]
  ds_read_b64_tr_b16 v[24:25], v10 offset:14400
  ds_read_b64_tr_b16 v[26:27], v10 offset:15168
  s_waitcnt lgkmcnt(5)
  v_mfma_f32_32x32x16_bf16 v[88:103], v[28:31], v[16:19], v[88:103]
  ds_read_b64_tr_b16 v[28:29], v10 offset:14464
  ds_read_b64_tr_b16 v[30:31], v10 offset:15232
  ds_read_b128 v[16:19], v7 offset:14336
  s_waitcnt lgkmcnt(5)
  v_mfma_f32_32x32x16_bf16 v[56:71], v[20:23], v[12:15], v[56:71]
  ds_read_b64_tr_b16 v[20:21], v10 offset:17408
  ds_read_b64_tr_b16 v[22:23], v10 offset:18176
  s_waitcnt lgkmcnt(5)
  v_mfma_f32_32x32x16_bf16 v[72:87], v[24:27], v[12:15], v[72:87]
  ds_read_b64_tr_b16 v[24:25], v10 offset:17472
  ds_read_b64_tr_b16 v[26:27], v10 offset:18240
  s_waitcnt lgkmcnt(5)
  v_mfma_f32_32x32x16_bf16 v[88:103], v[28:31], v[12:15], v[88:103]
  ds_read_b64_tr_b16 v[28:29], v10 offset:17536
  ds_read_b64_tr_b16 v[30:31], v10 offset:18304
  s_barrier
  ds_read_b128 v[12:15], v6 offset:28672
  s_waitcnt lgkmcnt(5)
  v_mfma_f32_32x32x16_bf16 v[56:71], v[20:23], v[16:19], v[56:71]
  ds_read_b64_tr_b16 v[20:21], v10 offset:28672
  ds_read_b64_tr_b16 v[22:23], v10 offset:29440
  s_waitcnt lgkmcnt(5)
  v_mfma_f32_32x32x16_bf16 v[72:87], v[24:27], v[16:19], v[72:87]
  ds_read_b64_tr_b16 v[24:25], v10 offset:28736
  ds_read_b64_tr_b16 v[26:27], v10 offset:29504
  s_waitcnt lgkmcnt(5)
  v_mfma_f32_32x32x16_bf16 v[88:103], v[28:31], v[16:19], v[88:103]
  ds_read_b64_tr_b16 v[28:29], v10 offset:28800
  ds_read_b64_tr_b16 v[30:31], v10 offset:29568
  ds_read_b128 v[16:19], v7 offset:28672
  s_waitcnt lgkmcnt(5)
  v_mfma_f32_32x32x16_bf16 v[56:71], v[20:23], v[12:15], v[56:71]
  ds_read_b64_tr_b16 v[20:21], v10 offset:31744
  ds_read_b64_tr_b16 v[22:23], v10 offset:32512
  s_waitcnt lgkmcnt(5)
  v_mfma_f32_32x32x16_bf16 v[72:87], v[24:27], v[12:15], v[72:87]
  ds_read_b64_tr_b16 v[24:25], v10 offset:31808
  ds_read_b64_tr_b16 v[26:27], v10 offset:32576
  s_waitcnt lgkmcnt(5)
  v_mfma_f32_32x32x16_bf16 v[88:103], v[28:31], v[12:15], v[88:103]
  ds_read_b64_tr_b16 v[28:29], v10 offset:31872
  ds_read_b64_tr_b16 v[30:31], v10 offset:32640
  s_barrier
  ds_read_b128 v[12:15], v8 offset:0
  s_waitcnt lgkmcnt(5)
  v_mfma_f32_32x32x16_bf16 v[56:71], v[20:23], v[16:19], v[56:71]
  ds_read_b64_tr_b16 v[20:21], v11 offset:0
  ds_read_b64_tr_b16 v[22:23], v11 offset:768
  s_waitcnt lgkmcnt(5)
  v_mfma_f32_32x32x16_bf16 v[72:87], v[24:27], v[16:19], v[72:87]
  ds_read_b64_tr_b16 v[24:25], v11 offset:64
  ds_read_b64_tr_b16 v[26:27], v11 offset:832
  s_waitcnt lgkmcnt(5)
  v_mfma_f32_32x32x16_bf16 v[88:103], v[28:31], v[16:19], v[88:103]
  ds_read_b64_tr_b16 v[28:29], v11 offset:128
  ds_read_b64_tr_b16 v[30:31], v11 offset:896
  ds_read_b128 v[16:19], v9 offset:0
  s_waitcnt lgkmcnt(5)
  v_mfma_f32_32x32x16_bf16 v[56:71], v[20:23], v[12:15], v[56:71]
  ds_read_b64_tr_b16 v[20:21], v11 offset:3072
  ds_read_b64_tr_b16 v[22:23], v11 offset:3840
  s_waitcnt lgkmcnt(5)
  v_mfma_f32_32x32x16_bf16 v[72:87], v[24:27], v[12:15], v[72:87]
  ds_read_b64_tr_b16 v[24:25], v11 offset:3136
  ds_read_b64_tr_b16 v[26:27], v11 offset:3904
  s_waitcnt lgkmcnt(5)
  v_mfma_f32_32x32x16_bf16 v[88:103], v[28:31], v[12:15], v[88:103]
  ds_read_b64_tr_b16 v[28:29], v11 offset:3200
  ds_read_b64_tr_b16 v[30:31], v11 offset:3968
  s_barrier
  ds_read_b128 v[12:15], v8 offset:14336
  s_waitcnt lgkmcnt(5)
  v_mfma_f32_32x32x16_bf16 v[56:71], v[20:23], v[16:19], v[56:71]
  ds_read_b64_tr_b16 v[20:21], v11 offset:14336
  ds_read_b64_tr_b16 v[22:23], v11 offset:15104
  s_waitcnt lgkmcnt(5)
  v_mfma_f32_32x32x16_bf16 v[72:87], v[24:27], v[16:19], v[72:87]
  ds_read_b64_tr_b16 v[24:25], v11 offset:14400
  ds_read_b64_tr_b16 v[26:27], v11 offset:15168
  s_waitcnt lgkmcnt(5)
  v_mfma_f32_32x32x16_bf16 v[88:103], v[28:31], v[16:19], v[88:103]
  ds_read_b64_tr_b16 v[28:29], v11 offset:14464
  ds_read_b64_tr_b16 v[30:31], v11 offset:15232
  ds_read_b128 v[16:19], v9 offset:14336
  s_waitcnt lgkmcnt(5)
  v_mfma_f32_32x32x16_bf16 v[56:71], v[20:23], v[12:15], v[56:71]
  ds_read_b64_tr_b16 v[20:21], v11 offset:17408
  ds_read_b64_tr_b16 v[22:23], v11 offset:18176
  s_waitcnt lgkmcnt(5)
  v_mfma_f32_32x32x16_bf16 v[72:87], v[24:27], v[12:15], v[72:87]
  ds_read_b64_tr_b16 v[24:25], v11 offset:17472
  ds_read_b64_tr_b16 v[26:27], v11 offset:18240
  s_waitcnt lgkmcnt(5)
  v_mfma_f32_32x32x16_bf16 v[88:103], v[28:31], v[12:15], v[88:103]
  ds_read_b64_tr_b16 v[28:29], v11 offset:17536
  ds_read_b64_tr_b16 v[30:31], v11 offset:18304
  s_barrier
  ds_read_b128 v[12:15], v6 offset:0
  s_waitcnt lgkmcnt(5)
  v_mfma_f32_32x32x16_bf16 v[56:71], v[20:23], v[16:19], v[56:71]
  ds_read_b64_tr_b16 v[20:21], v10 offset:0
  ds_read_b64_tr_b16 v[22:23], v10 offset:768
  s_waitcnt lgkmcnt(5)
  v_mfma_f32_32x32x16_bf16 v[72:87], v[24:27], v[16:19], v[72:87]
  ds_read_b64_tr_b16 v[24:25], v10 offset:64
  ds_read_b64_tr_b16 v[26:27], v10 offset:832
  s_waitcnt lgkmcnt(5)
  v_mfma_f32_32x32x16_bf16 v[88:103], v[28:31], v[16:19], v[88:103]
  ds_read_b64_tr_b16 v[28:29], v10 offset:128
  ds_read_b64_tr_b16 v[30:31], v10 offset:896
  s_sub_u32 s52, s52, 1
  s_cmp_lg_u32 s52, 0
  s_cbranch_scc1 fk_1_f1cl
  s_waitcnt lgkmcnt(0)
  s_setprio 3
  s_mul_i32 s42, s18, 6144
  v_and_b32 v2, 31, v1
  v_lshlrev_b32 v2, 6, v2
  v_lshrrev_b32 v3, 5, v1
  v_lshl_add_u32 v2, v3, 4, v2
  v_add_u32 v6, s42, v2
  v_lshlrev_b32 v7, 4, v1
  v_add_u32 v8, s42, v7
  s_mul_i32 s51, s41, 393216
  s_lshl_b32 s42, s40, 7
  s_lshl_b32 s43, s18, 5
  s_add_u32 s42, s42, s43
  s_lshl_b32 s42, s42, 6
  s_add_u32 s51, s51, s42
  s_add_u32 s51, s51, 8388608
  s_waitcnt vmcnt(0)
  s_nop 7
  v_max_f32 v56, 0, v56
  v_max_f32 v57, 0, v57
  v_max_f32 v58, 0, v58
  v_max_f32 v59, 0, v59
  v_max_f32 v60, 0, v60
  v_max_f32 v61, 0, v61
  v_max_f32 v62, 0, v62
  v_max_f32 v63, 0, v63
  v_pk_mul_f32 v[56:57], v[56:57], v[56:57]
  v_pk_mul_f32 v[58:59], v[58:59], v[58:59]
  v_pk_mul_f32 v[60:61], v[60:61], v[60:61]
  v_pk_mul_f32 v[62:63], v[62:63], v[62:63]
  v_cvt_pk_bf16_f32 v104, v56, v57
  v_cvt_pk_bf16_f32 v105, v58, v59
  v_cvt_pk_bf16_f32 v106, v60, v61
  v_cvt_pk_bf16_f32 v107, v62, v63
  ds_write_b128 v6, v[104:107] offset:0
  v_max_f32 v64, 0, v64
  v_max_f32 v65, 0, v65
  v_max_f32 v66, 0, v66
  v_max_f32 v67, 0, v67
  v_max_f32 v68, 0, v68
  v_max_f32 v69, 0, v69
  v_max_f32 v70, 0, v70
  v_max_f32 v71, 0, v71
  v_pk_mul_f32 v[64:65], v[64:65], v[64:65]
  v_pk_mul_f32 v[66:67], v[66:67], v[66:67]
  v_pk_mul_f32 v[68:69], v[68:69], v[68:69]
  v_pk_mul_f32 v[70:71], v[70:71], v[70:71]
  v_cvt_pk_bf16_f32 v108, v64, v65
  v_cvt_pk_bf16_f32 v109, v66, v67
  v_cvt_pk_bf16_f32 v110, v68, v69
  v_cvt_pk_bf16_f32 v111, v70, v71
  ds_write_b128 v6, v[108:111] offset:32
  v_max_f32 v72, 0, v72
  v_max_f32 v73, 0, v73
  v_max_f32 v74, 0, v74
  v_max_f32 v75, 0, v75
  v_max_f32 v76, 0, v76
  v_max_f32 v77, 0, v77
  v_max_f32 v78, 0, v78
  v_max_f32 v79, 0, v79
  v_pk_mul_f32 v[72:73], v[72:73], v[72:73]
  v_pk_mul_f32 v[74:75], v[74:75], v[74:75]
  v_pk_mul_f32 v[76:77], v[76:77], v[76:77]
  v_pk_mul_f32 v[78:79], v[78:79], v[78:79]
  v_cvt_pk_bf16_f32 v104, v72, v73
  v_cvt_pk_bf16_f32 v105, v74, v75
  v_cvt_pk_bf16_f32 v106, v76, v77
  v_cvt_pk_bf16_f32 v107, v78, v79
  ds_write_b128 v6, v[104:107] offset:2048
  v_max_f32 v80, 0, v80
  v_max_f32 v81, 0, v81
  v_max_f32 v82, 0, v82
  v_max_f32 v83, 0, v83
  v_max_f32 v84, 0, v84
  v_max_f32 v85, 0, v85
  v_max_f32 v86, 0, v86
  v_max_f32 v87, 0, v87
  v_pk_mul_f32 v[80:81], v[80:81], v[80:81]
  v_pk_mul_f32 v[82:83], v[82:83], v[82:83]
  v_pk_mul_f32 v[84:85], v[84:85], v[84:85]
  v_pk_mul_f32 v[86:87], v[86:87], v[86:87]
  v_cvt_pk_bf16_f32 v108, v80, v81
  v_cvt_pk_bf16_f32 v109, v82, v83
  v_cvt_pk_bf16_f32 v110, v84, v85
  v_cvt_pk_bf16_f32 v111, v86, v87
  ds_write_b128 v6, v[108:111] offset:2080
  v_max_f32 v88, 0, v88
  v_max_f32 v89, 0, v89
  v_max_f32 v90, 0, v90
  v_max_f32 v91, 0, v91
  v_max_f32 v92, 0, v92
  v_max_f32 v93, 0, v93
  v_max_f32 v94, 0, v94
  v_max_f32 v95, 0, v95
  v_pk_mul_f32 v[88:89], v[88:89], v[88:89]
  v_pk_mul_f32 v[90:91], v[90:91], v[90:91]
  v_pk_mul_f32 v[92:93], v[92:93], v[92:93]
  v_pk_mul_f32 v[94:95], v[94:95], v[94:95]
  v_cvt_pk_bf16_f32 v104, v88, v89
  v_cvt_pk_bf16_f32 v105, v90, v91
  v_cvt_pk_bf16_f32 v106, v92, v93
  v_cvt_pk_bf16_f32 v107, v94, v95
  ds_write_b128 v6, v[104:107] offset:4096
  v_max_f32 v96, 0, v96
  v_max_f32 v97, 0, v97
  v_max_f32 v98, 0, v98
  v_max_f32 v99, 0, v99
  v_max_f32 v100, 0, v100
  v_max_f32 v101, 0, v101
  v_max_f32 v102, 0, v102
  v_max_f32 v103, 0, v103
  v_pk_mul_f32 v[96:97], v[96:97], v[96:97]
  v_pk_mul_f32 v[98:99], v[98:99], v[98:99]
  v_pk_mul_f32 v[100:101], v[100:101], v[100:101]
  v_pk_mul_f32 v[102:103], v[102:103], v[102:103]
  v_cvt_pk_bf16_f32 v108, v96, v97
  v_cvt_pk_bf16_f32 v109, v98, v99
  v_cvt_pk_bf16_f32 v110, v100, v101
  v_cvt_pk_bf16_f32 v111, v102, v103
  ds_write_b128 v6, v[108:111] offset:4128
  s_waitcnt lgkmcnt(0)
  ds_read_b128 v[12:15], v8 offset:0
  ds_read_b128 v[16:19], v8 offset:1024
  ds_read_b128 v[20:23], v8 offset:2048
  ds_read_b128 v[24:27], v8 offset:3072
  ds_read_b128 v[28:31], v8 offset:4096
  ds_read_b128 v[32:35], v8 offset:5120
  s_waitcnt lgkmcnt(5)
  s_add_u32 s42, s51, 0
  buffer_store_dwordx4 v[12:15], v7, s[12:15], s42 offen sc1
  s_waitcnt lgkmcnt(4)
  s_add_u32 s42, s51, 1024
  buffer_store_dwordx4 v[16:19], v7, s[12:15], s42 offen sc1
  s_waitcnt lgkmcnt(3)
  s_add_u32 s42, s51, 131072
  buffer_store_dwordx4 v[20:23], v7, s[12:15], s42 offen sc1
  s_waitcnt lgkmcnt(2)
  s_add_u32 s42, s51, 132096
  buffer_store_dwordx4 v[24:27], v7, s[12:15], s42 offen sc1
  s_waitcnt lgkmcnt(1)
  s_add_u32 s42, s51, 262144
  buffer_store_dwordx4 v[28:31], v7, s[12:15], s42 offen sc1
  s_waitcnt lgkmcnt(0)
  s_add_u32 s42, s51, 263168
  buffer_store_dwordx4 v[32:35], v7, s[12:15], s42 offen sc1
fk_1_f1done:
  s_lshl_b32 s62, s40, 4
  s_add_u32 s62, s62, s41
  s_lshl_b32 s62, s62, 7
  s_add_u32 s62, s62, 19988480
  s_waitcnt vmcnt(0)
  s_barrier
  s_cmp_lg_u32 s18, 0
  s_cbranch_scc1 fk_pub6
  s_cmp_lg_u32 s60, 0
  s_cbranch_scc1 fk_gn_done7
  s_mov_b32 s61, 0
  v_mov_b32 v124, 0
fk_gn_loop7:
  global_load_dword v125, v124, s[56:57] sc0 sc1
  s_add_u32 s61, s61, 1
  s_waitcnt vmcnt(0)
  v_readfirstlane_b32 s60, v125
  s_cmp_gt_u32 s61, 0x20000
  s_cbranch_scc1 fk_exit
  s_cmp_eq_u32 s60, 0
  s_cbranch_scc1 fk_gn_loop7
fk_gn_done7:
  v_lshlrev_b32 v123, 4, v1
  v_mov_b32 v124, s60
  v_mov_b32 v125, s60
  v_mov_b32 v126, s60
  v_mov_b32 v127, s60
  s_mov_b64 exec, 0xff
  buffer_store_dwordx4 v[124:127], v123, s[12:15], s62 offen sc0 sc1
  s_mov_b64 exec, -1
fk_pub6:
  s_and_b32 s42, s19, 7
  s_lshr_b32 s43, s19, 3
  s_lshr_b32 s40, s42, 1
  s_lshl_b32 s40, s40, 3
  s_and_b32 s41, s43, 7
  s_add_u32 s40, s40, s41
  s_and_b32 s41, s42, 1
  s_lshl_b32 s41, s41, 2
  s_lshr_b32 s43, s43, 3
  s_add_u32 s41, s41, s43
  s_cmp_lt_u32 s18, 4
  s_cbranch_scc1 fk_f_f2c
  s_sub_u32 s49, s18, 4
  s_lshl_b32 s44, s49, 11
  s_mul_i32 s45, s49, 2560
  s_add_u32 s45, s45, 8192
  s_add_u32 s48, s40, s41
  s_mul_i32 s48, s48, 3
  s_cmp_ge_u32 s48, 96
  s_cselect_b32 s42, 96, 0
  s_sub_u32 s48, s48, s42
  s_cmp_ge_u32 s48, 48
  s_cselect_b32 s42, 48, 0
  s_sub_u32 s48, s48, s42
  s_cmp_ge_u32 s48, 24
  s_cselect_b32 s42, 24, 0
  s_sub_u32 s48, s48, s42
  s_barrier
  s_add_u32 m0, s44, 0
  s_lshl_b32 s46, s48, 18
  s_add_u32 s46, s46, 8388608
  s_mul_i32 s47, s48, 81920
  buffer_load_dwordx4 v40, s[12:15], s46 offen sc1 lds
  buffer_load_dwordx4 v40, s[12:15], s46 offen offset:1024 sc1 lds
  s_add_u32 m0, s45, 0
  s_add_u32 s48, s48, 1
  buffer_load_dwordx4 v41, s[24:27], s47 offen lds
  buffer_load_dwordx4 v42, s[24:27], s47 offen offset:1024 lds
  s_mov_b32 exec_hi, 0
  buffer_load_dwordx4 v43, s[24:27], s47 offen offset:2048 lds
  s_mov_b32 exec_hi, -1
  s_cmp_eq_u32 s48, 24
  s_cselect_b32 s48, 0, s48
  s_add_u32 m0, s44, 18432
  s_lshl_b32 s46, s48, 18
  s_add_u32 s46, s46, 8388608
  s_mul_i32 s47, s48, 81920
  buffer_load_dwordx4 v40, s[12:15], s46 offen sc1 lds
  buffer_load_dwordx4 v40, s[12:15], s46 offen offset:1024 sc1 lds
  s_add_u32 m0, s45, 18432
  s_add_u32 s48, s48, 1
  buffer_load_dwordx4 v41, s[24:27], s47 offen lds
  buffer_load_dwordx4 v42, s[24:27], s47 offen offset:1024 lds
  s_mov_b32 exec_hi, 0
  buffer_load_dwordx4 v43, s[24:27], s47 offen offset:2048 lds
  s_mov_b32 exec_hi, -1
  s_cmp_eq_u32 s48, 24
  s_cselect_b32 s48, 0, s48
  s_setprio 1
  s_waitcnt vmcnt(5)
  s_barrier
  s_add_u32 m0, s44, 36864
  s_lshl_b32 s46, s48, 18
  s_add_u32 s46, s46, 8388608
  s_mul_i32 s47, s48, 81920
  buffer_load_dwordx4 v40, s[12:15], s46 offen sc1 lds
  buffer_load_dwordx4 v40, s[12:15], s46 offen offset:1024 sc1 lds
  s_add_u32 m0, s45, 36864
  s_add_u32 s48, s48, 1
  buffer_load_dwordx4 v41, s[24:27], s47 offen lds
  buffer_load_dwordx4 v42, s[24:27], s47 offen offset:1024 lds
  s_mov_b32 exec_hi, 0
  buffer_load_dwordx4 v43, s[24:27], s47 offen offset:2048 lds
  s_mov_b32 exec_hi, -1
  s_cmp_eq_u32 s48, 24
  s_cselect_b32 s48, 0, s48
  s_mov_b32 s52, 5
fk_f_f2ll:
  s_waitcnt vmcnt(5)
  s_barrier
  s_add_u32 m0, s44, 55296
  s_lshl_b32 s46, s48, 18
  s_add_u32 s46, s46, 8388608
  s_mul_i32 s47, s48, 81920
  buffer_load_dwordx4 v40, s[12:15], s46 offen sc1 lds
  buffer_load_dwordx4 v40, s[12:15], s46 offen offset:1024 sc1 lds
  s_add_u32 m0, s45, 55296
  s_add_u32 s48, s48, 1
  buffer_load_dwordx4 v41, s[24:27], s47 offen lds
  buffer_load_dwordx4 v42, s[24:27], s47 offen offset:1024 lds
  s_mov_b32 exec_hi, 0
  buffer_load_dwordx4 v43, s[24:27], s47 offen offset:2048 lds
  s_mov_b32 exec_hi, -1
  s_cmp_eq_u32 s48, 24
  s_cselect_b32 s48, 0, s48
  s_waitcnt vmcnt(5)
  s_barrier
  s_add_u32 m0, s44, 0
  s_lshl_b32 s46, s48, 18
  s_add_u32 s46, s46, 8388608
  s_mul_i32 s47, s48, 81920
  buffer_load_dwordx4 v40, s[12:15], s46 offen sc1 lds
  buffer_load_dwordx4 v40, s[12:15], s46 offen offset:1024 sc1 lds
  s_add_u32 m0, s45, 0
  s_add_u32 s48, s48, 1
  buffer_load_dwordx4 v41, s[24:27], s47 offen lds
  buffer_load_dwordx4 v42, s[24:27], s47 offen offset:1024 lds
  s_mov_b32 exec_hi, 0
  buffer_load_dwordx4 v43, s[24:27], s47 offen offset:2048 lds
  s_mov_b32 exec_hi, -1
  s_cmp_eq_u32 s48, 24
  s_cselect_b32 s48, 0, s48
  s_waitcnt vmcnt(5)
  s_barrier
  s_add_u32 m0, s44, 18432
  s_lshl_b32 s46, s48, 18
  s_add_u32 s46, s46, 8388608
  s_mul_i32 s47, s48, 81920
  buffer_load_dwordx4 v40, s[12:15], s46 offen sc1 lds
  buffer_load_dwordx4 v40, s[12:15], s46 offen offset:1024 sc1 lds
  s_add_u32 m0, s45, 18432
  s_add_u32 s48, s48, 1
  buffer_load_dwordx4 v41, s[24:27], s47 offen lds
  buffer_load_dwordx4 v42, s[24:27], s47 offen offset:1024 lds
  s_mov_b32 exec_hi, 0
  buffer_load_dwordx4 v43, s[24:27], s47 offen offset:2048 lds
  s_mov_b32 exec_hi, -1
  s_cmp_eq_u32 s48, 24
  s_cselect_b32 s48, 0, s48
  s_waitcnt vmcnt(5)
  s_barrier
  s_add_u32 m0, s44, 36864
  s_lshl_b32 s46, s48, 18
  s_add_u32 s46, s46, 8388608
  s_mul_i32 s47, s48, 81920
  buffer_load_dwordx4 v40, s[12:15], s46 offen sc1 lds
  buffer_load_dwordx4 v40, s[12:15], s46 offen offset:1024 sc1 lds
  s_add_u32 m0, s45, 36864
  s_add_u32 s48, s48, 1
  buffer_load_dwordx4 v41, s[24:27], s47 offen lds
  buffer_load_dwordx4 v42, s[24:27], s47 offen offset:1024 lds
  s_mov_b32 exec_hi, 0
  buffer_load_dwordx4 v43, s[24:27], s47 offen offset:2048 lds
  s_mov_b32 exec_hi, -1
  s_cmp_eq_u32 s48, 24
  s_cselect_b32 s48, 0, s48
  s_sub_u32 s52, s52, 1
  s_cmp_lg_u32 s52, 0
  s_cbranch_scc1 fk_f_f2ll
  s_waitcnt vmcnt(5)
  s_barrier
  s_add_u32 m0, s44, 55296
  s_lshl_b32 s46, s48, 18
  s_add_u32 s46, s46, 8388608
  s_mul_i32 s47, s48, 81920
  buffer_load_dwordx4 v40, s[12:15], s46 offen sc1 lds
  buffer_load_dwordx4 v40, s[12:15], s46 offen offset:1024 sc1 lds
  s_add_u32 m0, s45, 55296
  s_add_u32 s48, s48, 1
  buffer_load_dwordx4 v41, s[24:27], s47 offen lds
  buffer_load_dwordx4 v42, s[24:27], s47 offen offset:1024 lds
  s_mov_b32 exec_hi, 0
  buffer_load_dwordx4 v43, s[24:27], s47 offen offset:2048 lds
  s_mov_b32 exec_hi, -1
  s_cmp_eq_u32 s48, 24
  s_cselect_b32 s48, 0, s48
  s_waitcnt vmcnt(5)
  s_barrier
  s_waitcnt vmcnt(0)
  s_barrier
  s_barrier
  s_setprio 3
  s_barrier
  s_add_u32 s48, s40, s41
  s_and_b32 s48, s48, 7
  s_mul_i32 s44, s49, 3072
  s_mul_i32 s45, s49, 3200
  s_add_u32 s45, s45, 12288
  s_mul_i32 s50, s49, 98304
  s_mul_i32 s42, s40, 3072
  s_add_u32 s50, s50, s42
  s_add_u32 s50, s50, 14680064
  s_add_u32 s42, s48, 0
  s_and_b32 s42, s42, 7
  s_add_u32 m0, s45, 0
  s_mul_i32 s47, s42, 102400
  buffer_load_dwordx4 v44, s[28:31], s47 offen offset:0 lds
  buffer_load_dwordx4 v45, s[28:31], s47 offen offset:1024 lds
  buffer_load_dwordx4 v46, s[28:31], s47 offen offset:2048 lds
  s_mov_b64 exec, 0xff
  buffer_load_dwordx4 v47, s[28:31], s47 offen offset:3072 lds
  s_mov_b64 exec, -1
  s_add_u32 s42, s48, 1
  s_and_b32 s42, s42, 7
  s_add_u32 m0, s45, 25088
  s_mul_i32 s47, s42, 102400
  buffer_load_dwordx4 v44, s[28:31], s47 offen offset:0 lds
  buffer_load_dwordx4 v45, s[28:31], s47 offen offset:1024 lds
  buffer_load_dwordx4 v46, s[28:31], s47 offen offset:2048 lds
  s_mov_b64 exec, 0xff
  buffer_load_dwordx4 v47, s[28:31], s47 offen offset:3072 lds
  s_mov_b64 exec, -1
  s_add_u32 s42, s48, 2
  s_and_b32 s42, s42, 7
  s_add_u32 m0, s45, 50176
  s_mul_i32 s47, s42, 102400
  buffer_load_dwordx4 v44, s[28:31], s47 offen offset:0 lds
  buffer_load_dwordx4 v45, s[28:31], s47 offen offset:1024 lds
  buffer_load_dwordx4 v46, s[28:31], s47 offen offset:2048 lds
  s_mov_b64 exec, 0xff
  buffer_load_dwordx4 v47, s[28:31], s47 offen offset:3072 lds
  s_mov_b64 exec, -1
  s_barrier
  s_add_u32 s42, s48, 0
  s_and_b32 s42, s42, 7
  s_add_u32 m0, s44, 0
  s_mul_i32 s46, s42, 393216
  s_add_u32 s46, s46, s50
  buffer_load_dwordx4 v48, s[12:15], s46 offen offset:0 sc1 lds
  buffer_load_dwordx4 v48, s[12:15], s46 offen offset:1024 sc1 lds
  buffer_load_dwordx4 v48, s[12:15], s46 offen offset:2048 sc1 lds
  s_add_u32 s42, s48, 1
  s_and_b32 s42, s42, 7
  s_add_u32 m0, s44, 25088
  s_mul_i32 s46, s42, 393216
  s_add_u32 s46, s46, s50
  buffer_load_dwordx4 v48, s[12:15], s46 offen offset:0 sc1 lds
  buffer_load_dwordx4 v48, s[12:15], s46 offen offset:1024 sc1 lds
  buffer_load_dwordx4 v48, s[12:15], s46 offen offset:2048 sc1 lds
  s_add_u32 s42, s48, 2
  s_and_b32 s42, s42, 7
  s_add_u32 m0, s44, 50176
  s_mul_i32 s46, s42, 393216
  s_add_u32 s46, s46, s50
  buffer_load_dwordx4 v48, s[12:15], s46 offen offset:0 sc1 lds
  buffer_load_dwordx4 v48, s[12:15], s46 offen offset:1024 sc1 lds
  buffer_load_dwordx4 v48, s[12:15], s46 offen offset:2048 sc1 lds
  s_waitcnt vmcnt(6)
  s_barrier
  s_waitcnt vmcnt(3)
  s_barrier
  s_add_u32 s42, s48, 3
  s_and_b32 s42, s42, 7
  s_add_u32 m0, s45, 0
  s_mul_i32 s47, s42, 102400
  buffer_load_dwordx4 v44, s[28:31], s47 offen offset:0 lds
  buffer_load_dwordx4 v45, s[28:31], s47 offen offset:1024 lds
  buffer_load_dwordx4 v46, s[28:31], s47 offen offset:2048 lds
  s_mov_b64 exec, 0xff
  buffer_load_dwordx4 v47, s[28:31], s47 offen offset:3072 lds
  s_mov_b64 exec, -1
  s_add_u32 s42, s48, 3
  s_and_b32 s42, s42, 7
  s_add_u32 m0, s44, 0
  s_mul_i32 s46, s42, 393216
  s_add_u32 s46, s46, s50
  buffer_load_dwordx4 v48, s[12:15], s46 offen offset:0 sc1 lds
  buffer_load_dwordx4 v48, s[12:15], s46 offen offset:1024 sc1 lds
  buffer_load_dwordx4 v48, s[12:15], s46 offen offset:2048 sc1 lds
  s_waitcnt vmcnt(7)
  s_barrier
  s_add_u32 s42, s48, 4
  s_and_b32 s42, s42, 7
  s_add_u32 m0, s45, 25088
  s_mul_i32 s47, s42, 102400
  buffer_load_dwordx4 v44, s[28:31], s47 offen offset:0 lds
  buffer_load_dwordx4 v45, s[28:31], s47 offen offset:1024 lds
  buffer_load_dwordx4 v46, s[28:31], s47 offen offset:2048 lds
  s_mov_b64 exec, 0xff
  buffer_load_dwordx4 v47, s[28:31], s47 offen offset:3072 lds
  s_mov_b64 exec, -1
  s_add_u32 s42, s48, 4
  s_and_b32 s42, s42, 7
  s_add_u32 m0, s44, 25088
  s_mul_i32 s46, s42, 393216
  s_add_u32 s46, s46, s50
  buffer_load_dwordx4 v48, s[12:15], s46 offen offset:0 sc1 lds
  buffer_load_dwordx4 v48, s[12:15], s46 offen offset:1024 sc1 lds
  buffer_load_dwordx4 v48, s[12:15], s46 offen offset:2048 sc1 lds
  s_waitcnt vmcnt(7)
  s_barrier
  s_add_u32 s42, s48, 5
  s_and_b32 s42, s42, 7
  s_add_u32 m0, s45, 50176
  s_mul_i32 s47, s42, 102400
  buffer_load_dwordx4 v44, s[28:31], s47 offen offset:0 lds
  buffer_load_dwordx4 v45, s[28:31], s47 offen offset:1024 lds
  buffer_load_dwordx4 v46, s[28:31], s47 offen offset:2048 lds
  s_mov_b64 exec, 0xff
  buffer_load_dwordx4 v47, s[28:31], s47 offen offset:3072 lds
  s_mov_b64 exec, -1
  s_add_u32 s42, s48, 5
  s_and_b32 s42, s42, 7
  s_add_u32 m0, s44, 50176
  s_mul_i32 s46, s42, 393216
  s_add_u32 s46, s46, s50
  buffer_load_dwordx4 v48, s[12:15], s46 offen offset:0 sc1 lds
  buffer_load_dwordx4 v48, s[12:15], s46 offen offset:1024 sc1 lds
  buffer_load_dwordx4 v48, s[12:15], s46 offen offset:2048 sc1 lds
  s_waitcnt vmcnt(7)
  s_barrier
  s_add_u32 s42, s48, 6
  s_and_b32 s42, s42, 7
  s_add_u32 m0, s45, 0
  s_mul_i32 s47, s42, 102400
  buffer_load_dwordx4 v44, s[28:31], s47 offen offset:0 lds
  buffer_load_dwordx4 v45, s[28:31], s47 offen offset:1024 lds
  buffer_load_dwordx4 v46, s[28:31], s47 offen offset:2048 lds
  s_mov_b64 exec, 0xff
  buffer_load_dwordx4 v47, s[28:31], s47 offen offset:3072 lds
  s_mov_b64 exec, -1
  s_add_u32 s42, s48, 6
  s_and_b32 s42, s42, 7
  s_add_u32 m0, s44, 0
  s_mul_i32 s46, s42, 393216
  s_add_u32 s46, s46, s50
  buffer_load_dwordx4 v48, s[12:15], s46 offen offset:0 sc1 lds
  buffer_load_dwordx4 v48, s[12:15], s46 offen offset:1024 sc1 lds
  buffer_load_dwordx4 v48, s[12:15], s46 offen offset:2048 sc1 lds
  s_waitcnt vmcnt(7)
  s_barrier
  s_add_u32 s42, s48, 7
  s_and_b32 s42, s42, 7
  s_add_u32 m0, s45, 25088
  s_mul_i32 s47, s42, 102400
  buffer_load_dwordx4 v44, s[28:31], s47 offen offset:0 lds
  buffer_load_dwordx4 v45, s[28:31], s47 offen offset:1024 lds
  buffer_load_dwordx4 v46, s[28:31], s47 offen offset:2048 lds
  s_mov_b64 exec, 0xff
  buffer_load_dwordx4 v47, s[28:31], s47 offen offset:3072 lds
  s_mov_b64 exec, -1
  s_add_u32 s42, s48, 7
  s_and_b32 s42, s42, 7
  s_add_u32 m0, s44, 25088
  s_mul_i32 s46, s42, 393216
  s_add_u32 s46, s46, s50
  buffer_load_dwordx4 v48, s[12:15], s46 offen offset:0 sc1 lds
  buffer_load_dwordx4 v48, s[12:15], s46 offen offset:1024 sc1 lds
  buffer_load_dwordx4 v48, s[12:15], s46 offen offset:2048 sc1 lds
  s_waitcnt vmcnt(7)
  s_barrier
  s_waitcnt vmcnt(0)
  s_barrier
  s_barrier
  s_branch fk_f_f2done
fk_f_f2c:
  s_lshl_b32 s42, s40, 6
  s_lshl_b32 s43, s18, 4
  s_add_u32 s42, s42, s43
  v_and_b32 v2, 15, v1
  v_add_u32 v2, s42, v2
  v_mul_u32_u24 v13, 1280, v2
  v_lshlrev_b32 v12, 2, v2
  v_lshrrev_b32 v3, 4, v1
  v_lshlrev_b32 v4, 3, v3
  s_mul_i32 s42, s41, 160
  v_add_u32 v4, s42, v4
  v_add_u32 v13, v13, v4
  buffer_load_dwordx2 v[14:15], v4, s[32:35], 0 offen offset:0
  buffer_load_dwordx2 v[16:17], v4, s[32:35], 0 offen offset:32
  buffer_load_dwordx2 v[18:19], v4, s[32:35], 0 offen offset:64
  buffer_load_dwordx2 v[20:21], v4, s[32:35], 0 offen offset:96
  buffer_load_dwordx2 v[22:23], v4, s[32:35], 0 offen offset:128
  v_and_b32 v2, 15, v1
  v_lshrrev_b32 v4, 2, v2
  v_sub_u32 v4, 0, v4
  v_and_b32 v4, 3, v4
  v_xor_b32 v4, v4, v3
  v_lshlrev_b32 v4, 4, v4
  v_lshl_add_u32 v4, v2, 6, v4
  s_lshl_b32 s42, s18, 10
  v_add_u32 v6, s42, v4
  v_add_u32 v8, 36864, v6
  v_lshrrev_b32 v4, 1, v3
  v_lshlrev_b32 v4, 4, v4
  v_and_b32 v5, 1, v3
  v_lshl_add_u32 v4, v5, 2, v4
  v_bfe_u32 v5, v1, 2, 2
  v_add_u32 v4, v4, v5
  v_mul_u32_u24 v4, 160, v4
  v_and_b32 v5, 3, v1
  v_lshl_add_u32 v4, v5, 3, v4
  v_add_u32 v10, 8192, v4
  v_add_u32 v11, 36864, v10
  v_add_u32 v121, 12288, v4
  v_mul_u32_u24 v120, 3072, v3
  v_mul_u32_u24 v2, 48, v2
  v_add_u32 v120, v120, v2
  s_mul_i32 s42, s18, 768
  v_add_u32 v120, s42, v120
  v_bfe_u32 v2, v1, 2, 2
  v_lshl_add_u32 v2, v3, 2, v2
  v_add_u32 v2, 64, v2
  v_mul_u32_u24 v2, 160, v2
  v_lshl_add_u32 v2, v5, 3, v2
  v_add_u32 v122, 12288, v2
  s_cmp_lg_u32 s18, 0
  s_cbranch_scc1 fk_wh10
  s_cmp_lg_u32 s60, 0
  s_cbranch_scc1 fk_gn_done11
  s_mov_b32 s61, 0
  v_mov_b32 v124, 0
fk_gn_loop11:
  global_load_dword v125, v124, s[56:57] sc0 sc1
  s_add_u32 s61, s61, 1
  s_waitcnt vmcnt(0)
  v_readfirstlane_b32 s60, v125
  s_cmp_gt_u32 s61, 0x20000
  s_cbranch_scc1 fk_exit
  s_cmp_eq_u32 s60, 0
  s_cbranch_scc1 fk_gn_loop11
fk_gn_done11:
  s_lshr_b32 s62, s40, 1
  s_lshl_b32 s62, s62, 11
  s_add_u32 s62, s62, 19988480
  v_lshlrev_b32 v124, 7, v1
  v_add_u32 v124, s62, v124
  s_mov_b32 s61, 0
  s_mov_b32 exec_lo, 65535
  s_mov_b32 exec_hi, 0
fk_pl12:
  buffer_load_dword v125, v124, s[12:15], 0 offen sc0 sc1
  s_add_u32 s61, s61, 1
  s_waitcnt vmcnt(0)
  v_cmp_ne_u32 vcc, s60, v125
  s_cmp_gt_u32 s61, 0x20000
  s_cbranch_scc1 fk_exit_full
  s_cbranch_vccz fk_pd12
  s_sleep 4
  s_branch fk_pl12
fk_pd12:
  s_mov_b64 exec, -1
fk_wh10:
  s_barrier
  s_mov_b32 s42, 18874368
  buffer_load_dword v12, v12, s[12:15], s42 offen sc1
  v_mov_b32 v72, 0
  v_mov_b32 v73, 0
  v_mov_b32 v74, 0
  v_mov_b32 v75, 0
  v_mov_b32 v76, 0
  v_mov_b32 v77, 0
  v_mov_b32 v78, 0
  v_mov_b32 v79, 0
  v_mov_b32 v80, 0
  v_mov_b32 v81, 0
  v_mov_b32 v82, 0
  v_mov_b32 v83, 0
  v_mov_b32 v84, 0
  v_mov_b32 v85, 0
  v_mov_b32 v86, 0
  v_mov_b32 v87, 0
  v_mov_b32 v88, 0
  v_mov_b32 v89, 0
  v_mov_b32 v90, 0
  v_mov_b32 v91, 0
  v_mov_b32 v92, 0
  v_mov_b32 v93, 0
  v_mov_b32 v94, 0
  v_mov_b32 v95, 0
  v_mov_b32 v96, 0
  v_mov_b32 v97, 0
  v_mov_b32 v98, 0
  v_mov_b32 v99, 0
  v_mov_b32 v100, 0
  v_mov_b32 v101, 0
  v_mov_b32 v102, 0
  v_mov_b32 v103, 0
  v_mov_b32 v104, 0
  v_mov_b32 v105, 0
  v_mov_b32 v106, 0
  v_mov_b32 v107, 0
  v_mov_b32 v108, 0
  v_mov_b32 v109, 0
  v_mov_b32 v110, 0
  v_mov_b32 v111, 0
  s_mov_b32 s52, 6
  s_barrier
  s_setprio 0
  ds_read_b128 v[24:27], v6 offset:0
  ds_read_b64_tr_b16 v[28:29], v10 offset:0
  ds_read_b64_tr_b16 v[30:31], v10 offset:1280
  ds_read_b64_tr_b16 v[32:33], v10 offset:32
  ds_read_b64_tr_b16 v[34:35], v10 offset:1312
  ds_read_b64_tr_b16 v[36:37], v10 offset:64
  ds_read_b64_tr_b16 v[38:39], v10 offset:1344
  ds_read_b64_tr_b16 v[40:41], v10 offset:96
  ds_read_b64_tr_b16 v[42:43], v10 offset:1376
  ds_read_b64_tr_b16 v[44:45], v10 offset:128
  ds_read_b64_tr_b16 v[46:47], v10 offset:1408
.p2align 6
fk_f_f2cl:
  ds_read_b128 v[48:51], v6 offset:4096
  ds_read_b64_tr_b16 v[52:53], v10 offset:5120
  ds_read_b64_tr_b16 v[54:55], v10 offset:6400
  ds_read_b64_tr_b16 v[56:57], v10 offset:5152
  ds_read_b64_tr_b16 v[58:59], v10 offset:6432
  ds_read_b64_tr_b16 v[60:61], v10 offset:5184
  ds_read_b64_tr_b16 v[62:63], v10 offset:6464
  ds_read_b64_tr_b16 v[64:65], v10 offset:5216
  ds_read_b64_tr_b16 v[66:67], v10 offset:6496
  ds_read_b64_tr_b16 v[68:69], v10 offset:5248
  ds_read_b64_tr_b16 v[70:71], v10 offset:6528
  s_waitcnt lgkmcnt(11)
  v_mfma_f32_16x16x32_bf16 v[72:75], v[28:31], v[24:27], v[72:75]
  v_mfma_f32_16x16x32_bf16 v[76:79], v[32:35], v[24:27], v[76:79]
  v_mfma_f32_16x16x32_bf16 v[80:83], v[36:39], v[24:27], v[80:83]
  v_mfma_f32_16x16x32_bf16 v[84:87], v[40:43], v[24:27], v[84:87]
  v_mfma_f32_16x16x32_bf16 v[88:91], v[44:47], v[24:27], v[88:91]
  s_barrier
  ds_read_b128 v[24:27], v6 offset:18432
  ds_read_b64_tr_b16 v[28:29], v10 offset:18432
  ds_read_b64_tr_b16 v[30:31], v10 offset:19712
  ds_read_b64_tr_b16 v[32:33], v10 offset:18464
  ds_read_b64_tr_b16 v[34:35], v10 offset:19744
  ds_read_b64_tr_b16 v[36:37], v10 offset:18496
  ds_read_b64_tr_b16 v[38:39], v10 offset:19776
  ds_read_b64_tr_b16 v[40:41], v10 offset:18528
  ds_read_b64_tr_b16 v[42:43], v10 offset:19808
  ds_read_b64_tr_b16 v[44:45], v10 offset:18560
  ds_read_b64_tr_b16 v[46:47], v10 offset:19840
  s_waitcnt lgkmcnt(11)
  v_mfma_f32_16x16x32_bf16 v[72:75], v[52:55], v[48:51], v[72:75]
  v_mfma_f32_16x16x32_bf16 v[76:79], v[56:59], v[48:51], v[76:79]
  v_mfma_f32_16x16x32_bf16 v[80:83], v[60:63], v[48:51], v[80:83]
  v_mfma_f32_16x16x32_bf16 v[84:87], v[64:67], v[48:51], v[84:87]
  v_mfma_f32_16x16x32_bf16 v[88:91], v[68:71], v[48:51], v[88:91]
  ds_read_b128 v[48:51], v6 offset:22528
  ds_read_b64_tr_b16 v[52:53], v10 offset:23552
  ds_read_b64_tr_b16 v[54:55], v10 offset:24832
  ds_read_b64_tr_b16 v[56:57], v10 offset:23584
  ds_read_b64_tr_b16 v[58:59], v10 offset:24864
  ds_read_b64_tr_b16 v[60:61], v10 offset:23616
  ds_read_b64_tr_b16 v[62:63], v10 offset:24896
  ds_read_b64_tr_b16 v[64:65], v10 offset:23648
  ds_read_b64_tr_b16 v[66:67], v10 offset:24928
  ds_read_b64_tr_b16 v[68:69], v10 offset:23680
  ds_read_b64_tr_b16 v[70:71], v10 offset:24960
  s_waitcnt lgkmcnt(11)
  v_mfma_f32_16x16x32_bf16 v[72:75], v[28:31], v[24:27], v[72:75]
  v_mfma_f32_16x16x32_bf16 v[76:79], v[32:35], v[24:27], v[76:79]
  v_mfma_f32_16x16x32_bf16 v[80:83], v[36:39], v[24:27], v[80:83]
  v_mfma_f32_16x16x32_bf16 v[84:87], v[40:43], v[24:27], v[84:87]
  v_mfma_f32_16x16x32_bf16 v[88:91], v[44:47], v[24:27], v[88:91]
  s_barrier
  ds_read_b128 v[24:27], v8 offset:0
  ds_read_b64_tr_b16 v[28:29], v11 offset:0
  ds_read_b64_tr_b16 v[30:31], v11 offset:1280
  ds_read_b64_tr_b16 v[32:33], v11 offset:32
  ds_read_b64_tr_b16 v[34:35], v11 offset:1312
  ds_read_b64_tr_b16 v[36:37], v11 offset:64
  ds_read_b64_tr_b16 v[38:39], v11 offset:1344
  ds_read_b64_tr_b16 v[40:41], v11 offset:96
  ds_read_b64_tr_b16 v[42:43], v11 offset:1376
  ds_read_b64_tr_b16 v[44:45], v11 offset:128
  ds_read_b64_tr_b16 v[46:47], v11 offset:1408
  s_waitcnt lgkmcnt(11)
  v_mfma_f32_16x16x32_bf16 v[72:75], v[52:55], v[48:51], v[72:75]
  v_mfma_f32_16x16x32_bf16 v[76:79], v[56:59], v[48:51], v[76:79]
  v_mfma_f32_16x16x32_bf16 v[80:83], v[60:63], v[48:51], v[80:83]
  v_mfma_f32_16x16x32_bf16 v[84:87], v[64:67], v[48:51], v[84:87]
  v_mfma_f32_16x16x32_bf16 v[88:91], v[68:71], v[48:51], v[88:91]
  ds_read_b128 v[48:51], v8 offset:4096
  ds_read_b64_tr_b16 v[52:53], v11 offset:5120
  ds_read_b64_tr_b16 v[54:55], v11 offset:6400
  ds_read_b64_tr_b16 v[56:57], v11 offset:5152
  ds_read_b64_tr_b16 v[58:59], v11 offset:6432
  ds_read_b64_tr_b16 v[60:61], v11 offset:5184
  ds_read_b64_tr_b16 v[62:63], v11 offset:6464
  ds_read_b64_tr_b16 v[64:65], v11 offset:5216
  ds_read_b64_tr_b16 v[66:67], v11 offset:6496
  ds_read_b64_tr_b16 v[68:69], v11 offset:5248
  ds_read_b64_tr_b16 v[70:71], v11 offset:6528
  s_waitcnt lgkmcnt(11)
  v_mfma_f32_16x16x32_bf16 v[72:75], v[28:31], v[24:27], v[72:75]
  v_mfma_f32_16x16x32_bf16 v[76:79], v[32:35], v[24:27], v[76:79]
  v_mfma_f32_16x16x32_bf16 v[80:83], v[36:39], v[24:27], v[80:83]
  v_mfma_f32_16x16x32_bf16 v[84:87], v[40:43], v[24:27], v[84:87]
  v_mfma_f32_16x16x32_bf16 v[88:91], v[44:47], v[24:27], v[88:91]
  s_barrier
  ds_read_b128 v[24:27], v8 offset:18432
  ds_read_b64_tr_b16 v[28:29], v11 offset:18432
  ds_read_b64_tr_b16 v[30:31], v11 offset:19712
  ds_read_b64_tr_b16 v[32:33], v11 offset:18464
  ds_read_b64_tr_b16 v[34:35], v11 offset:19744
  ds_read_b64_tr_b16 v[36:37], v11 offset:18496
  ds_read_b64_tr_b16 v[38:39], v11 offset:19776
  ds_read_b64_tr_b16 v[40:41], v11 offset:18528
  ds_read_b64_tr_b16 v[42:43], v11 offset:19808
  ds_read_b64_tr_b16 v[44:45], v11 offset:18560
  ds_read_b64_tr_b16 v[46:47], v11 offset:19840
  s_waitcnt lgkmcnt(11)
  v_mfma_f32_16x16x32_bf16 v[72:75], v[52:55], v[48:51], v[72:75]
  v_mfma_f32_16x16x32_bf16 v[76:79], v[56:59], v[48:51], v[76:79]
  v_mfma_f32_16x16x32_bf16 v[80:83], v[60:63], v[48:51], v[80:83]
  v_mfma_f32_16x16x32_bf16 v[84:87], v[64:67], v[48:51], v[84:87]
  v_mfma_f32_16x16x32_bf16 v[88:91], v[68:71], v[48:51], v[88:91]
  ds_read_b128 v[48:51], v8 offset:22528
  ds_read_b64_tr_b16 v[52:53], v11 offset:23552
  ds_read_b64_tr_b16 v[54:55], v11 offset:24832
  ds_read_b64_tr_b16 v[56:57], v11 offset:23584
  ds_read_b64_tr_b16 v[58:59], v11 offset:24864
  ds_read_b64_tr_b16 v[60:61], v11 offset:23616
  ds_read_b64_tr_b16 v[62:63], v11 offset:24896
  ds_read_b64_tr_b16 v[64:65], v11 offset:23648
  ds_read_b64_tr_b16 v[66:67], v11 offset:24928
  ds_read_b64_tr_b16 v[68:69], v11 offset:23680
  ds_read_b64_tr_b16 v[70:71], v11 offset:24960
  s_waitcnt lgkmcnt(11)
  v_mfma_f32_16x16x32_bf16 v[72:75], v[28:31], v[24:27], v[72:75]
  v_mfma_f32_16x16x32_bf16 v[76:79], v[32:35], v[24:27], v[76:79]
  v_mfma_f32_16x16x32_bf16 v[80:83], v[36:39], v[24:27], v[80:83]
  v_mfma_f32_16x16x32_bf16 v[84:87], v[40:43], v[24:27], v[84:87]
  v_mfma_f32_16x16x32_bf16 v[88:91], v[44:47], v[24:27], v[88:91]
  s_barrier
  ds_read_b128 v[24:27], v6 offset:0
  ds_read_b64_tr_b16 v[28:29], v10 offset:0
  ds_read_b64_tr_b16 v[30:31], v10 offset:1280
  ds_read_b64_tr_b16 v[32:33], v10 offset:32
  ds_read_b64_tr_b16 v[34:35], v10 offset:1312
  ds_read_b64_tr_b16 v[36:37], v10 offset:64
  ds_read_b64_tr_b16 v[38:39], v10 offset:1344
  ds_read_b64_tr_b16 v[40:41], v10 offset:96
  ds_read_b64_tr_b16 v[42:43], v10 offset:1376
  ds_read_b64_tr_b16 v[44:45], v10 offset:128
  ds_read_b64_tr_b16 v[46:47], v10 offset:1408
  s_waitcnt lgkmcnt(11)
  v_mfma_f32_16x16x32_bf16 v[72:75], v[52:55], v[48:51], v[72:75]
  v_mfma_f32_16x16x32_bf16 v[76:79], v[56:59], v[48:51], v[76:79]
  v_mfma_f32_16x16x32_bf16 v[80:83], v[60:63], v[48:51], v[80:83]
  v_mfma_f32_16x16x32_bf16 v[84:87], v[64:67], v[48:51], v[84:87]
  v_mfma_f32_16x16x32_bf16 v[88:91], v[68:71], v[48:51], v[88:91]
  s_sub_u32 s52, s52, 1
  s_cmp_lg_u32 s52, 0
  s_cbranch_scc1 fk_f_f2cl
  s_waitcnt lgkmcnt(0)
  s_setprio 3
  s_barrier
  s_waitcnt vmcnt(0)
  v_sub_f32 v5, 1.0, v12
  s_nop 7
  v_lshlrev_b32 v4, 16, v14
  v_add_f32 v72, v72, v4
  v_mul_f32 v72, v72, v5
  v_and_b32 v4, 0xffff0000, v14
  v_add_f32 v73, v73, v4
  v_mul_f32 v73, v73, v5
  v_lshlrev_b32 v4, 16, v15
  v_add_f32 v74, v74, v4
  v_mul_f32 v74, v74, v5
  v_and_b32 v4, 0xffff0000, v15
  v_add_f32 v75, v75, v4
  v_mul_f32 v75, v75, v5
  v_lshlrev_b32 v4, 16, v16
  v_add_f32 v76, v76, v4
  v_mul_f32 v76, v76, v5
  v_and_b32 v4, 0xffff0000, v16
  v_add_f32 v77, v77, v4
  v_mul_f32 v77, v77, v5
  v_lshlrev_b32 v4, 16, v17
  v_add_f32 v78, v78, v4
  v_mul_f32 v78, v78, v5
  v_and_b32 v4, 0xffff0000, v17
  v_add_f32 v79, v79, v4
  v_mul_f32 v79, v79, v5
  v_lshlrev_b32 v4, 16, v18
  v_add_f32 v80, v80, v4
  v_mul_f32 v80, v80, v5
  v_and_b32 v4, 0xffff0000, v18
  v_add_f32 v81, v81, v4
  v_mul_f32 v81, v81, v5
  v_lshlrev_b32 v4, 16, v19
  v_add_f32 v82, v82, v4
  v_mul_f32 v82, v82, v5
  v_and_b32 v4, 0xffff0000, v19
  v_add_f32 v83, v83, v4
  v_mul_f32 v83, v83, v5
  v_lshlrev_b32 v4, 16, v20
  v_add_f32 v84, v84, v4
  v_mul_f32 v84, v84, v5
  v_and_b32 v4, 0xffff0000, v20
  v_add_f32 v85, v85, v4
  v_mul_f32 v85, v85, v5
  v_lshlrev_b32 v4, 16, v21
  v_add_f32 v86, v86, v4
  v_mul_f32 v86, v86, v5
  v_and_b32 v4, 0xffff0000, v21
  v_add_f32 v87, v87, v4
  v_mul_f32 v87, v87, v5
  v_lshlrev_b32 v4, 16, v22
  v_add_f32 v88, v88, v4
  v_mul_f32 v88, v88, v5
  v_and_b32 v4, 0xffff0000, v22
  v_add_f32 v89, v89, v4
  v_mul_f32 v89, v89, v5
  v_lshlrev_b32 v4, 16, v23
  v_add_f32 v90, v90, v4
  v_mul_f32 v90, v90, v5
  v_and_b32 v4, 0xffff0000, v23
  v_add_f32 v91, v91, v4
  v_mul_f32 v91, v91, v5
  s_cmp_lg_u32 s18, 0
  s_cbranch_scc1 fk_wo13
  s_lshr_b32 s62, s40, 2
  s_lshl_b32 s62, s62, 12
  s_add_u32 s62, s62, 20021248
  v_lshlrev_b32 v124, 7, v1
  v_add_u32 v124, s62, v124
  s_mov_b32 s61, 0
  s_mov_b32 exec_lo, -1
  s_mov_b32 exec_hi, 0
fk_pl14:
  buffer_load_dword v125, v124, s[12:15], 0 offen sc0 sc1
  s_add_u32 s61, s61, 1
  s_waitcnt vmcnt(0)
  v_cmp_ne_u32 vcc, s60, v125
  s_cmp_gt_u32 s61, 0x20000
  s_cbranch_scc1 fk_exit_full
  s_cbranch_vccz fk_pd14
  s_sleep 4
  s_branch fk_pl14
fk_pd14:
  s_mov_b64 exec, -1
fk_wo13:
  s_barrier
  s_setprio 3
  s_barrier
  s_mov_b32 s52, 4
  s_mov_b32 s53, 0
  ds_read_b128 v[24:27], v120 offset:0
  ds_read_b64_tr_b16 v[28:29], v121 offset:0
  ds_read_b64_tr_b16 v[30:31], v121 offset:1280
  ds_read_b64_tr_b16 v[32:33], v121 offset:32
  ds_read_b64_tr_b16 v[34:35], v121 offset:1312
  ds_read_b64_tr_b16 v[36:37], v121 offset:64
  ds_read_b64_tr_b16 v[38:39], v121 offset:1344
  ds_read_b64_tr_b16 v[40:41], v121 offset:96
  ds_read_b64_tr_b16 v[42:43], v121 offset:1376
  ds_read_b64_tr_b16 v[44:45], v121 offset:128
  ds_read_b64_tr_b16 v[46:47], v121 offset:1408
.p2align 6
fk_f_f3cl:
  s_add_u32 s53, s53, 25088
  s_cmp_ge_u32 s53, 75264
  s_cselect_b32 s53, 0, s53
  s_mov_b32 s54, 25088
  s_cmov_b32 s54, -50176
  v_add_u32 v123, s54, v120
  v_add_u32 v124, s54, v121
  v_add_u32 v125, s54, v122
  ds_read_b128 v[48:51], v120 offset:16
  ds_read_b64_tr_b16 v[52:53], v121 offset:5120
  ds_read_b64_tr_b16 v[54:55], v121 offset:6400
  ds_read_b64_tr_b16 v[56:57], v121 offset:5152
  ds_read_b64_tr_b16 v[58:59], v121 offset:6432
  ds_read_b64_tr_b16 v[60:61], v121 offset:5184
  ds_read_b64_tr_b16 v[62:63], v121 offset:6464
  ds_read_b64_tr_b16 v[64:65], v121 offset:5216
  ds_read_b64_tr_b16 v[66:67], v121 offset:6496
  ds_read_b64_tr_b16 v[68:69], v121 offset:5248
  ds_read_b64_tr_b16 v[70:71], v121 offset:6528
  s_waitcnt lgkmcnt(11)
  v_mfma_f32_16x16x32_bf16 v[92:95], v[28:31], v[24:27], v[92:95]
  v_mfma_f32_16x16x32_bf16 v[96:99], v[32:35], v[24:27], v[96:99]
  v_mfma_f32_16x16x32_bf16 v[100:103], v[36:39], v[24:27], v[100:103]
  v_mfma_f32_16x16x32_bf16 v[104:107], v[40:43], v[24:27], v[104:107]
  v_mfma_f32_16x16x32_bf16 v[108:111], v[44:47], v[24:27], v[108:111]
  ds_read_b128 v[24:27], v120 offset:32
  ds_read_b64_tr_b16 v[28:29], v122 offset:0
  ds_read_b64_tr_b16 v[32:33], v122 offset:32
  ds_read_b64_tr_b16 v[36:37], v122 offset:64
  ds_read_b64_tr_b16 v[40:41], v122 offset:96
  ds_read_b64_tr_b16 v[44:45], v122 offset:128
  s_waitcnt lgkmcnt(6)
  v_mfma_f32_16x16x32_bf16 v[92:95], v[52:55], v[48:51], v[92:95]
  v_mfma_f32_16x16x32_bf16 v[96:99], v[56:59], v[48:51], v[96:99]
  v_mfma_f32_16x16x32_bf16 v[100:103], v[60:63], v[48:51], v[100:103]
  v_mfma_f32_16x16x32_bf16 v[104:107], v[64:67], v[48:51], v[104:107]
  v_mfma_f32_16x16x32_bf16 v[108:111], v[68:71], v[48:51], v[108:111]
  s_waitcnt lgkmcnt(0)
  s_barrier
  ds_read_b128 v[48:51], v123 offset:0
  ds_read_b64_tr_b16 v[52:53], v124 offset:0
  ds_read_b64_tr_b16 v[54:55], v124 offset:1280
  ds_read_b64_tr_b16 v[56:57], v124 offset:32
  ds_read_b64_tr_b16 v[58:59], v124 offset:1312
  ds_read_b64_tr_b16 v[60:61], v124 offset:64
  ds_read_b64_tr_b16 v[62:63], v124 offset:1344
  ds_read_b64_tr_b16 v[64:65], v124 offset:96
  ds_read_b64_tr_b16 v[66:67], v124 offset:1376
  ds_read_b64_tr_b16 v[68:69], v124 offset:128
  ds_read_b64_tr_b16 v[70:71], v124 offset:1408
  s_waitcnt lgkmcnt(11)
  v_mfma_f32_16x16x32_bf16 v[92:95], v[28:31], v[24:27], v[92:95]
  v_mfma_f32_16x16x32_bf16 v[96:99], v[32:35], v[24:27], v[96:99]
  v_mfma_f32_16x16x32_bf16 v[100:103], v[36:39], v[24:27], v[100:103]
  v_mfma_f32_16x16x32_bf16 v[104:107], v[40:43], v[24:27], v[104:107]
  v_mfma_f32_16x16x32_bf16 v[108:111], v[44:47], v[24:27], v[108:111]
  v_mov_b32 v120, v123
  v_mov_b32 v121, v124
  v_mov_b32 v122, v125
  s_add_u32 s53, s53, 25088
  s_cmp_ge_u32 s53, 75264
  s_cselect_b32 s53, 0, s53
  s_mov_b32 s54, 25088
  s_cmov_b32 s54, -50176
  v_add_u32 v123, s54, v120
  v_add_u32 v124, s54, v121
  v_add_u32 v125, s54, v122
  ds_read_b128 v[24:27], v120 offset:16
  ds_read_b64_tr_b16 v[28:29], v121 offset:5120
  ds_read_b64_tr_b16 v[30:31], v121 offset:6400
  ds_read_b64_tr_b16 v[32:33], v121 offset:5152
  ds_read_b64_tr_b16 v[34:35], v121 offset:6432
  ds_read_b64_tr_b16 v[36:37], v121 offset:5184
  ds_read_b64_tr_b16 v[38:39], v121 offset:6464
  ds_read_b64_tr_b16 v[40:41], v121 offset:5216
  ds_read_b64_tr_b16 v[42:43], v121 offset:6496
  ds_read_b64_tr_b16 v[44:45], v121 offset:5248
  ds_read_b64_tr_b16 v[46:47], v121 offset:6528
  s_waitcnt lgkmcnt(11)
  v_mfma_f32_16x16x32_bf16 v[92:95], v[52:55], v[48:51], v[92:95]
  v_mfma_f32_16x16x32_bf16 v[96:99], v[56:59], v[48:51], v[96:99]
  v_mfma_f32_16x16x32_bf16 v[100:103], v[60:63], v[48:51], v[100:103]
  v_mfma_f32_16x16x32_bf16 v[104:107], v[64:67], v[48:51], v[104:107]
  v_mfma_f32_16x16x32_bf16 v[108:111], v[68:71], v[48:51], v[108:111]
  ds_read_b128 v[48:51], v120 offset:32
  ds_read_b64_tr_b16 v[52:53], v122 offset:0
  ds_read_b64_tr_b16 v[56:57], v122 offset:32
  ds_read_b64_tr_b16 v[60:61], v122 offset:64
  ds_read_b64_tr_b16 v[64:65], v122 offset:96
  ds_read_b64_tr_b16 v[68:69], v122 offset:128
  s_waitcnt lgkmcnt(6)
  v_mfma_f32_16x16x32_bf16 v[92:95], v[28:31], v[24:27], v[92:95]
  v_mfma_f32_16x16x32_bf16 v[96:99], v[32:35], v[24:27], v[96:99]
  v_mfma_f32_16x16x32_bf16 v[100:103], v[36:39], v[24:27], v[100:103]
  v_mfma_f32_16x16x32_bf16 v[104:107], v[40:43], v[24:27], v[104:107]
  v_mfma_f32_16x16x32_bf16 v[108:111], v[44:47], v[24:27], v[108:111]
  s_waitcnt lgkmcnt(0)
  s_barrier
  ds_read_b128 v[24:27], v123 offset:0
  ds_read_b64_tr_b16 v[28:29], v124 offset:0
  ds_read_b64_tr_b16 v[30:31], v124 offset:1280
  ds_read_b64_tr_b16 v[32:33], v124 offset:32
  ds_read_b64_tr_b16 v[34:35], v124 offset:1312
  ds_read_b64_tr_b16 v[36:37], v124 offset:64
  ds_read_b64_tr_b16 v[38:39], v124 offset:1344
  ds_read_b64_tr_b16 v[40:41], v124 offset:96
  ds_read_b64_tr_b16 v[42:43], v124 offset:1376
  ds_read_b64_tr_b16 v[44:45], v124 offset:128
  ds_read_b64_tr_b16 v[46:47], v124 offset:1408
  s_waitcnt lgkmcnt(11)
  v_mfma_f32_16x16x32_bf16 v[92:95], v[52:55], v[48:51], v[92:95]
  v_mfma_f32_16x16x32_bf16 v[96:99], v[56:59], v[48:51], v[96:99]
  v_mfma_f32_16x16x32_bf16 v[100:103], v[60:63], v[48:51], v[100:103]
  v_mfma_f32_16x16x32_bf16 v[104:107], v[64:67], v[48:51], v[104:107]
  v_mfma_f32_16x16x32_bf16 v[108:111], v[68:71], v[48:51], v[108:111]
  v_mov_b32 v120, v123
  v_mov_b32 v121, v124
  v_mov_b32 v122, v125
  s_sub_u32 s52, s52, 1
  s_cmp_lg_u32 s52, 0
  s_cbranch_scc1 fk_f_f3cl
  s_waitcnt lgkmcnt(0)
  s_nop 7
  v_fma_f32 v72, v92, v12, v72
  v_fma_f32 v73, v93, v12, v73
  v_fma_f32 v74, v94, v12, v74
  v_fma_f32 v75, v95, v12, v75
  v_cvt_pk_bf16_f32 v112, v72, v73
  v_cvt_pk_bf16_f32 v113, v74, v75
  buffer_store_dwordx2 v[112:113], v13, s[36:39], 0 offen offset:0
  v_fma_f32 v76, v96, v12, v76
  v_fma_f32 v77, v97, v12, v77
  v_fma_f32 v78, v98, v12, v78
  v_fma_f32 v79, v99, v12, v79
  v_cvt_pk_bf16_f32 v114, v76, v77
  v_cvt_pk_bf16_f32 v115, v78, v79
  buffer_store_dwordx2 v[114:115], v13, s[36:39], 0 offen offset:32
  v_fma_f32 v80, v100, v12, v80
  v_fma_f32 v81, v101, v12, v81
  v_fma_f32 v82, v102, v12, v82
  v_fma_f32 v83, v103, v12, v83
  v_cvt_pk_bf16_f32 v116, v80, v81
  v_cvt_pk_bf16_f32 v117, v82, v83
  buffer_store_dwordx2 v[116:117], v13, s[36:39], 0 offen offset:64
  v_fma_f32 v84, v104, v12, v84
  v_fma_f32 v85, v105, v12, v85
  v_fma_f32 v86, v106, v12, v86
  v_fma_f32 v87, v107, v12, v87
  v_cvt_pk_bf16_f32 v118, v84, v85
  v_cvt_pk_bf16_f32 v119, v86, v87
  buffer_store_dwordx2 v[118:119], v13, s[36:39], 0 offen offset:96
  v_fma_f32 v88, v108, v12, v88
  v_fma_f32 v89, v109, v12, v89
  v_fma_f32 v90, v110, v12, v90
  v_fma_f32 v91, v111, v12, v91
  v_cvt_pk_bf16_f32 v112, v88, v89
  v_cvt_pk_bf16_f32 v113, v90, v91
  buffer_store_dwordx2 v[112:113], v13, s[36:39], 0 offen offset:128
fk_f_f2done:
fk_end:
  s_branch fk_exit
fk_exit_full:
  s_mov_b64 exec, -1
fk_exit:
  s_endpgm
.section .rodata,"a"
.p2align 6
.amdhsa_kernel main_kernel
  .amdhsa_next_free_vgpr 128
  .amdhsa_next_free_sgpr 96
  .amdhsa_accum_offset 128
  .amdhsa_group_segment_fixed_size 0
  .amdhsa_kernarg_size 96
  .amdhsa_user_sgpr_count 2
  .amdhsa_user_sgpr_kernarg_segment_ptr 1
  .amdhsa_system_sgpr_workgroup_id_x 1
.end_amdhsa_kernel
.text
```
